```python
import torch

def _softmax(x, axis=-1):
    return torch.softmax(x, dim=axis)

def _gelu(x):
    return torch.nn.functional.gelu(x, approximate='tanh')

def _silu(x):
    return torch.nn.functional.silu(x)

def _sigmoid(x):
    return torch.sigmoid(x)

def _layernorm(x, axis=-1, eps=1e-05):
    m = x.mean(dim=axis, keepdim=True)
    v = x.var(dim=axis, keepdim=True, unbiased=False)
    return (x - m) / torch.sqrt(v + eps)

def _scatter_add(tgt, idx, src, axis=0):
    return tgt.clone().index_add_(axis, idx, src)

def _segment_sum(src, seg, n):
    out = torch.zeros((n,) + src.shape[1:], dtype=src.dtype)
    return out.index_add_(0, seg, src)

def _pad(x, pw):
    flat = tuple((v for pair in reversed(pw) for v in pair))
    return torch.nn.functional.pad(x, flat)
kernel_name = 'standalone__tree_speculative_verify_tree_attention_over_candidate_token_tree__prompt'

def setup_inputs():

    _w = lambda a: (lambda t: t.to(torch.bfloat16) if t.is_floating_point() else t)(torch.as_tensor(a))
    B, Hq, Hkv, T, C, D = (1, 32, 16, 2048, 2048, 128)
    tree_mask = torch.zeros((B, T, T), dtype=float)
    for b in range(B):
        parent = torch.zeros(T, dtype=torch.int64)
        for i in range(1, T):
            parent[i] = int(torch.randint(0, i, (1,)).item())
        for i in range(T):
            j = i
            tree_mask[b, i, j] = 1.0
            while j > 0:
                j = parent[j]
                tree_mask[b, i, j] = 1.0
    return {'q': _w((lambda *s: torch.randn(*s, dtype=torch.bfloat16) * 0.8)(B, Hq, T, D)), 'k_cache': _w((lambda *s: torch.randn(*s, dtype=torch.bfloat16) * 0.8)(B, Hkv, C, D)), 'v_cache': _w((lambda *s: torch.randn(*s, dtype=torch.bfloat16) * 0.05)(B, Hkv, C, D)), 'k_tree': _w((lambda *s: torch.randn(*s, dtype=torch.bfloat16) * 0.8)(B, Hkv, T, D)), 'v_tree': _w((lambda *s: torch.randn(*s, dtype=torch.bfloat16) * 0.05)(B, Hkv, T, D)), 'tree_mask': _w(tree_mask)}

def reference(q, k_cache, v_cache, k_tree, v_tree, tree_mask):
    B, Hq, T, D = q.shape
    Hkv, C = (k_cache.shape[1], k_cache.shape[2])
    rep = Hq // Hkv
    kc = (lambda x, n, axis: torch.repeat_interleave(x, n, dim=axis))(k_cache, rep, axis=1)
    vc = (lambda x, n, axis: torch.repeat_interleave(x, n, dim=axis))(v_cache, rep, axis=1)
    kt = (lambda x, n, axis: torch.repeat_interleave(x, n, dim=axis))(k_tree, rep, axis=1)
    vt = (lambda x, n, axis: torch.repeat_interleave(x, n, dim=axis))(v_tree, rep, axis=1)
    k = torch.concatenate([kc, kt], axis=2)
    v = torch.concatenate([vc, vt], axis=2)
    scale = D ** (-0.5)
    scores = torch.einsum('bhqd,bhkd->bhqk', q, k) * scale
    ctx_mask = torch.ones((B, 1, T, C), dtype=scores.dtype)
    tm = tree_mask[:, None, :, :].clone()
    full_mask = torch.concatenate([ctx_mask, tm], axis=-1)
    scores = scores + (1.0 - full_mask) * -1000000000.0
    p = _softmax(scores, axis=-1)
    return torch.einsum('bhqk,bhkd->bhqd', p, v)
```

```asm
; @launch grid=(256,1,1) block=(256,1,1) lds=163840
.amdgcn_target "amdgcn-amd-amdhsa--gfx950"
.text
.globl standalone__tree_speculative_verify_tree_attention_over_candidate_token_tree__prompt_kernel
.p2align 8
.type standalone__tree_speculative_verify_tree_attention_over_candidate_token_tree__prompt_kernel,@function
standalone__tree_speculative_verify_tree_attention_over_candidate_token_tree__prompt_kernel:
    s_cmp_ge_u32 s2, 256
    s_cbranch_scc1 L_end_standalone__tree_speculative_verify_tree_attention_over_candidate_token_tree__prompt_kernel
    s_load_dwordx16 s[4:19], s[0:1], 0
    s_load_dwordx2 s[20:21], s[0:1], 64
    s_getpc_b64 s[22:23]
L_pc_standalone__tree_speculative_verify_tree_attention_over_candidate_token_tree__prompt_kernel:
    v_lshlrev_b32 v34, 7, v0
    v_min_u32 v34, L_end_standalone__tree_speculative_verify_tree_attention_over_candidate_token_tree__prompt_kernel-L_pc_standalone__tree_speculative_verify_tree_attention_over_candidate_token_tree__prompt_kernel, v34
    global_load_dword v95, v34, s[22:23]
    v_and_b32 v1, 63, v0
    v_lshrrev_b32 v35, 6, v0
    s_and_b32 s60, s2, 7
    s_lshl_b32 s60, s60, 1
    s_lshr_b32 s61, s2, 3
    s_and_b32 s61, s61, 1
    s_or_b32 s52, s60, s61
    s_lshr_b32 s53, s2, 4
    v_readfirstlane_b32 s54, v35
    v_and_b32 v32, 15, v1
    v_lshrrev_b32 v33, 4, v1
    s_lshl_b32 s58, s54, 12
    s_lshl_b32 s78, s54, 14
    s_add_u32 s78, s78, 81920
    v_lshlrev_b32 v35, 8, v33
    v_add_u32 v36, 0, v33
    v_lshlrev_b32 v36, 1, v36
    v_xor_b32 v36, v36, v32
    v_lshlrev_b32 v16, 4, v36
    v_add_u32 v42, v16, v35
    v_add_u32 v14, s58, v42
    v_add_u32 v36, 4, v33
    v_lshlrev_b32 v36, 1, v36
    v_xor_b32 v36, v36, v32
    v_lshlrev_b32 v17, 4, v36
    v_add_u32 v43, v17, v35
    v_add_u32 v15, s58, v43
    s_lshl_b32 s63, s52, 19
    s_lshl_b32 s59, s53, 7
    s_lshl_b32 s61, s54, 5
    s_add_u32 s59, s59, s61
    s_lshl_b32 s60, s52, 20
    s_lshl_b32 s61, s59, 8
    s_add_u32 s60, s60, s61
    s_mov_b32 s55, 0
    s_mov_b32 s56, 0
    s_waitcnt lgkmcnt(0)
    s_add_u32 s24, s6, s63
    s_addc_u32 s25, s7, 0
    s_and_b32 s25, s25, 0xffff
    s_mov_b32 s26, 0x80000
    s_mov_b32 s27, 0x20000
    s_add_u32 s32, s4, s60
    s_addc_u32 s33, s5, 0
    s_and_b32 s33, s33, 0xffff
    s_mov_b32 s34, 0x100000
    s_mov_b32 s35, 0x20000
    s_sub_u32 s34, 1048576, s61
    v_lshlrev_b32 v246, 4, v1
    s_mov_b32 s4, s14
    s_and_b32 s5, s15, 0xffff
    s_mov_b32 s6, 0x800000
    s_mov_b32 s7, 0x20000
    s_lshl_b32 s98, s2, 15
    s_lshl_b32 s99, s54, 10
    s_add_u32 s98, s98, s99
    s_add_u32 m0, s58, 0
    s_nop 0
    buffer_load_dwordx4 v14, s[24:27], s55 offen offset:0  lds
    buffer_load_dwordx4 v15, s[24:27], s55 offen offset:1024  lds
    buffer_load_dwordx4 v14, s[24:27], s55 offen offset:2048  lds
    buffer_load_dwordx4 v15, s[24:27], s55 offen offset:3072  lds
    s_add_u32 m0, s78, 0
    s_mov_b32 s62, 0
    buffer_load_dwordx4 v42, s[32:35], s62 offen offset:0 nt lds
    buffer_load_dwordx4 v43, s[32:35], s62 offen offset:1024 nt lds
    s_add_u32 m0, s78, 2048
    s_mov_b32 s62, 524288
    buffer_load_dwordx4 v42, s[32:35], s62 offen offset:0 nt lds
    buffer_load_dwordx4 v43, s[32:35], s62 offen offset:1024 nt lds
    s_add_u32 m0, s78, 4096
    s_mov_b32 s62, 2048
    buffer_load_dwordx4 v42, s[32:35], s62 offen offset:0 nt lds
    buffer_load_dwordx4 v43, s[32:35], s62 offen offset:1024 nt lds
    s_add_u32 m0, s78, 6144
    s_mov_b32 s62, 526336
    buffer_load_dwordx4 v42, s[32:35], s62 offen offset:0 nt lds
    buffer_load_dwordx4 v43, s[32:35], s62 offen offset:1024 nt lds
    s_mov_b32 s48, s20
    s_and_b32 s49, s21, 0xffff
    s_mov_b32 s50, 0x10000000
    s_mov_b32 s51, 0x20000
    s_add_u32 s28, s8, s63
    s_addc_u32 s29, s9, 0
    s_and_b32 s29, s29, 0xffff
    s_mov_b32 s30, 0x80000
    s_mov_b32 s31, 0x20000
    s_add_u32 s40, s10, s63
    s_addc_u32 s41, s11, 0
    s_and_b32 s41, s41, 0xffff
    s_mov_b32 s42, 0x80000
    s_mov_b32 s43, 0x20000
    s_add_u32 s44, s12, s63
    s_addc_u32 s45, s13, 0
    s_and_b32 s45, s45, 0xffff
    s_mov_b32 s46, 0x80000
    s_mov_b32 s47, 0x20000
    s_add_u32 s36, s16, s60
    s_addc_u32 s37, s17, 0
    s_and_b32 s37, s37, 0xffff
    s_mov_b32 s38, 0x100000
    s_mov_b32 s39, 0x20000
    s_mov_b32 s38, s34
    v_mov_b32 v44, 0
    v_mov_b32 v45, 0
    v_mov_b32 v46, 0
    v_mov_b32 v47, 0
    v_and_b32 v37, 7, v32
    v_lshlrev_b32 v37, 1, v37
    v_mfma_f32_32x32x16_bf16 a[0:15], v[44:47], v[44:47], 0
    v_add_u32 v36, 0, v33
    v_xor_b32 v36, v36, v37
    v_lshlrev_b32 v36, 4, v36
    v_lshl_add_u32 v2, v32, 8, v36
    v_add_u32 v21, s78, v2
    v_mfma_f32_32x32x16_bf16 a[16:31], v[44:47], v[44:47], 0
    v_add_u32 v36, 4, v33
    v_xor_b32 v36, v36, v37
    v_lshlrev_b32 v36, 4, v36
    v_lshl_add_u32 v3, v32, 8, v36
    v_add_u32 v22, s78, v3
    v_mfma_f32_32x32x16_bf16 a[32:47], v[44:47], v[44:47], 0
    v_add_u32 v36, 8, v33
    v_xor_b32 v36, v36, v37
    v_lshlrev_b32 v36, 4, v36
    v_lshl_add_u32 v4, v32, 8, v36
    v_add_u32 v23, s78, v4
    v_mfma_f32_32x32x16_bf16 a[48:63], v[44:47], v[44:47], 0
    v_add_u32 v36, 12, v33
    v_xor_b32 v36, v36, v37
    v_lshlrev_b32 v36, 4, v36
    v_lshl_add_u32 v5, v32, 8, v36
    v_add_u32 v24, s78, v5
    v_mfma_f32_32x32x16_bf16 a[64:79], v[44:47], v[44:47], 0
    v_mfma_f32_32x32x16_bf16 a[80:95], v[44:47], v[44:47], 0
    v_mfma_f32_32x32x16_bf16 a[96:111], v[44:47], v[44:47], 0
    v_mfma_f32_32x32x16_bf16 a[112:127], v[44:47], v[44:47], 0
    v_mfma_f32_32x32x16_bf16 a[184:199], v[44:47], v[44:47], 0
    v_lshrrev_b32 v36, 2, v32
    v_lshl_add_u32 v36, v33, 2, v36
    v_and_b32 v37, 7, v36
    v_lshlrev_b32 v37, 1, v37
    v_bfe_u32 v38, v32, 1, 1
    v_xor_b32 v37, v37, v38
    v_and_b32 v38, 1, v32
    v_lshlrev_b32 v38, 3, v38
    v_lshl_add_u32 v38, v36, 8, v38
    v_xor_b32 v36, 0, v37
    v_lshl_add_u32 v6, v36, 4, v38
    v_xor_b32 v36, 2, v37
    v_lshl_add_u32 v7, v36, 4, v38
    v_xor_b32 v36, 4, v37
    v_lshl_add_u32 v8, v36, 4, v38
    v_xor_b32 v36, 6, v37
    v_lshl_add_u32 v9, v36, 4, v38
    v_xor_b32 v36, 8, v37
    v_lshl_add_u32 v10, v36, 4, v38
    v_xor_b32 v36, 10, v37
    v_lshl_add_u32 v11, v36, 4, v38
    v_xor_b32 v36, 12, v37
    v_lshl_add_u32 v12, v36, 4, v38
    v_xor_b32 v36, 14, v37
    v_lshl_add_u32 v13, v36, 4, v38
    v_and_b32 v36, 3, v1
    v_mov_b32 v37, 0x3f803f80
    v_cmp_gt_u32 vcc, 2, v36
    v_mov_b32 v18, 0x44444444
    v_mov_b32 v38, 0xeeeeeeee
    v_cndmask_b32 v34, 0, v37, vcc
    v_cmp_eq_u32 vcc, 1, v36
    v_accvgpr_write_b32 a200, v34
    v_accvgpr_write_b32 a201, v34
    v_accvgpr_write_b32 a202, v34
    v_accvgpr_write_b32 a203, v34
    v_cndmask_b32 v18, v18, v38, vcc
    v_cmp_eq_u32 vcc, 0, v36
    s_nop 1
    v_cndmask_b32 v34, 0, v37, vcc
    v_accvgpr_write_b32 a248, v34
    v_accvgpr_write_b32 a249, v34
    v_accvgpr_write_b32 a250, v34
    v_accvgpr_write_b32 a251, v34
    s_lshl_b32 s89, s53, 2
    s_add_u32 s89, s89, s54
    s_lshl_b32 s61, s89, 9
    v_and_b32 v249, 31, v1
    v_lshlrev_b32 v249, 4, v249
    v_add_u32 v249, s61, v249
    s_mov_b32 s68, 98304
    s_lshr_b32 s60, s59, 3
    s_lshl_b32 s77, s60, 17
    v_lshlrev_b32 v19, 5, v33
    v_add_u32 v20, 1024, v246
    v_mov_b32 v236, 0x80000000
    v_mov_b32 v237, v236
    v_mov_b32 v238, v236
    v_mov_b32 v239, v236
    v_mov_b32 v240, v236
    v_mov_b32 v241, v236
    v_mov_b32 v242, v236
    v_mov_b32 v243, v236
    s_lshl_b32 s69, s89, 10
    s_sub_u32 s69, s69, 196608
    s_mov_b32 s76, 0
    s_mov_b32 s82, 32
    s_mov_b32 s83, 32
    s_mov_b32 s97, 4
    s_mov_b32 s96, 0
    s_mov_b32 s23, 0
    v_and_b32 v36, 3, v1
    v_lshlrev_b32 v36, 2, v36
    v_add_u32 v253, 160256, v36
    s_lshl_b32 s60, s54, 2
    s_add_u32 s60, s60, 160256
    v_mov_b32 v255, s60
    v_mov_b32 v248, 0
    v_mov_b32 v36, 160320
    ds_write_b32 v255, v248
    ds_write_b32 v36, v248
    s_mov_b32 s90, 0
    s_mov_b32 s91, 16384
    s_mov_b32 s92, 32768
    s_mov_b32 s94, 0x400000e5
    v_add_u32 v25, s78, v6
    v_add_u32 v26, s78, v7
    v_add_u32 v27, s78, v8
    v_add_u32 v28, s78, v9
    v_add_u32 v29, s78, v10
    v_add_u32 v30, s78, v11
    v_add_u32 v31, s78, v12
    v_add_u32 v0, s78, v13
    v_add_u32 v6, 49152, v6
    v_add_u32 v7, 49152, v7
    v_add_u32 v8, 49152, v8
    v_add_u32 v9, 49152, v9
    v_add_u32 v10, 49152, v10
    v_add_u32 v11, 49152, v11
    v_add_u32 v12, 49152, v12
    v_add_u32 v13, 49152, v13
    s_add_u32 m0, s78, 8192
    s_mov_b32 s62, 4096
    buffer_load_dwordx4 v42, s[32:35], s62 offen offset:0 nt lds
    buffer_load_dwordx4 v43, s[32:35], s62 offen offset:1024 nt lds
    s_add_u32 m0, s78, 10240
    s_mov_b32 s62, 528384
    buffer_load_dwordx4 v42, s[32:35], s62 offen offset:0 nt lds
    buffer_load_dwordx4 v43, s[32:35], s62 offen offset:1024 nt lds
    s_add_u32 m0, s78, 12288
    s_mov_b32 s62, 6144
    buffer_load_dwordx4 v42, s[32:35], s62 offen offset:0 nt lds
    buffer_load_dwordx4 v43, s[32:35], s62 offen offset:1024 nt lds
    s_add_u32 m0, s78, 14336
    s_mov_b32 s62, 530432
    buffer_load_dwordx4 v42, s[32:35], s62 offen offset:0 nt lds
    buffer_load_dwordx4 v43, s[32:35], s62 offen offset:1024 nt lds
    s_mov_b32 s88, 0x3e0293ee
    s_mov_b32 s95, 0xffff0000
    s_waitcnt vmcnt(12)
    ds_read_b128 v[160:163], v21 offset:0
    ds_read_b128 v[164:167], v22 offset:0
    ds_read_b128 v[168:171], v23 offset:0
    ds_read_b128 v[172:175], v24 offset:0
    s_waitcnt lgkmcnt(0)
    v_lshlrev_b32 v36, 16, v160
    v_and_b32 v37, s95, v160
    v_lshlrev_b32 v38, 16, v161
    v_and_b32 v39, s95, v161
    v_mul_f32 v36, s88, v36
    v_mul_f32 v37, s88, v37
    v_mul_f32 v38, s88, v38
    v_mul_f32 v39, s88, v39
    v_cvt_pk_bf16_f32 v160, v36, v37
    v_cvt_pk_bf16_f32 v161, v38, v39
    v_lshlrev_b32 v36, 16, v162
    v_and_b32 v37, s95, v162
    v_lshlrev_b32 v38, 16, v163
    v_and_b32 v39, s95, v163
    v_mul_f32 v36, s88, v36
    v_mul_f32 v37, s88, v37
    v_mul_f32 v38, s88, v38
    v_mul_f32 v39, s88, v39
    v_cvt_pk_bf16_f32 v162, v36, v37
    v_cvt_pk_bf16_f32 v163, v38, v39
    v_lshlrev_b32 v36, 16, v164
    v_and_b32 v37, s95, v164
    v_lshlrev_b32 v38, 16, v165
    v_and_b32 v39, s95, v165
    v_mul_f32 v36, s88, v36
    v_mul_f32 v37, s88, v37
    v_mul_f32 v38, s88, v38
    v_mul_f32 v39, s88, v39
    v_cvt_pk_bf16_f32 v164, v36, v37
    v_cvt_pk_bf16_f32 v165, v38, v39
    v_lshlrev_b32 v36, 16, v166
    v_and_b32 v37, s95, v166
    v_lshlrev_b32 v38, 16, v167
    v_and_b32 v39, s95, v167
    v_mul_f32 v36, s88, v36
    v_mul_f32 v37, s88, v37
    v_mul_f32 v38, s88, v38
    v_mul_f32 v39, s88, v39
    v_cvt_pk_bf16_f32 v166, v36, v37
    v_cvt_pk_bf16_f32 v167, v38, v39
    v_lshlrev_b32 v36, 16, v168
    v_and_b32 v37, s95, v168
    v_lshlrev_b32 v38, 16, v169
    v_and_b32 v39, s95, v169
    v_mul_f32 v36, s88, v36
    v_mul_f32 v37, s88, v37
    v_mul_f32 v38, s88, v38
    v_mul_f32 v39, s88, v39
    v_cvt_pk_bf16_f32 v168, v36, v37
    v_cvt_pk_bf16_f32 v169, v38, v39
    v_lshlrev_b32 v36, 16, v170
    v_and_b32 v37, s95, v170
    v_lshlrev_b32 v38, 16, v171
    v_and_b32 v39, s95, v171
    v_mul_f32 v36, s88, v36
    v_mul_f32 v37, s88, v37
    v_mul_f32 v38, s88, v38
    v_mul_f32 v39, s88, v39
    v_cvt_pk_bf16_f32 v170, v36, v37
    v_cvt_pk_bf16_f32 v171, v38, v39
    v_lshlrev_b32 v36, 16, v172
    v_and_b32 v37, s95, v172
    v_lshlrev_b32 v38, 16, v173
    v_and_b32 v39, s95, v173
    v_mul_f32 v36, s88, v36
    v_mul_f32 v37, s88, v37
    v_mul_f32 v38, s88, v38
    v_mul_f32 v39, s88, v39
    v_cvt_pk_bf16_f32 v172, v36, v37
    v_cvt_pk_bf16_f32 v173, v38, v39
    v_lshlrev_b32 v36, 16, v174
    v_and_b32 v37, s95, v174
    v_lshlrev_b32 v38, 16, v175
    v_and_b32 v39, s95, v175
    v_mul_f32 v36, s88, v36
    v_mul_f32 v37, s88, v37
    v_mul_f32 v38, s88, v38
    v_mul_f32 v39, s88, v39
    v_cvt_pk_bf16_f32 v174, v36, v37
    v_cvt_pk_bf16_f32 v175, v38, v39
    s_waitcnt vmcnt(8)
    ds_read_b128 v[176:179], v21 offset:4096
    ds_read_b128 v[180:183], v22 offset:4096
    ds_read_b128 v[184:187], v23 offset:4096
    ds_read_b128 v[188:191], v24 offset:4096
    s_waitcnt lgkmcnt(0)
    v_lshlrev_b32 v36, 16, v176
    v_and_b32 v37, s95, v176
    v_lshlrev_b32 v38, 16, v177
    v_and_b32 v39, s95, v177
    v_mul_f32 v36, s88, v36
    v_mul_f32 v37, s88, v37
    v_mul_f32 v38, s88, v38
    v_mul_f32 v39, s88, v39
    v_cvt_pk_bf16_f32 v176, v36, v37
    v_cvt_pk_bf16_f32 v177, v38, v39
    v_lshlrev_b32 v36, 16, v178
    v_and_b32 v37, s95, v178
    v_lshlrev_b32 v38, 16, v179
    v_and_b32 v39, s95, v179
    v_mul_f32 v36, s88, v36
    v_mul_f32 v37, s88, v37
    v_mul_f32 v38, s88, v38
    v_mul_f32 v39, s88, v39
    v_cvt_pk_bf16_f32 v178, v36, v37
    v_cvt_pk_bf16_f32 v179, v38, v39
    v_lshlrev_b32 v36, 16, v180
    v_and_b32 v37, s95, v180
    v_lshlrev_b32 v38, 16, v181
    v_and_b32 v39, s95, v181
    v_mul_f32 v36, s88, v36
    v_mul_f32 v37, s88, v37
    v_mul_f32 v38, s88, v38
    v_mul_f32 v39, s88, v39
    v_cvt_pk_bf16_f32 v180, v36, v37
    v_cvt_pk_bf16_f32 v181, v38, v39
    v_lshlrev_b32 v36, 16, v182
    v_and_b32 v37, s95, v182
    v_lshlrev_b32 v38, 16, v183
    v_and_b32 v39, s95, v183
    v_mul_f32 v36, s88, v36
    v_mul_f32 v37, s88, v37
    v_mul_f32 v38, s88, v38
    v_mul_f32 v39, s88, v39
    v_cvt_pk_bf16_f32 v182, v36, v37
    v_cvt_pk_bf16_f32 v183, v38, v39
    v_lshlrev_b32 v36, 16, v184
    v_and_b32 v37, s95, v184
    v_lshlrev_b32 v38, 16, v185
    v_and_b32 v39, s95, v185
    v_mul_f32 v36, s88, v36
    v_mul_f32 v37, s88, v37
    v_mul_f32 v38, s88, v38
    v_mul_f32 v39, s88, v39
    v_cvt_pk_bf16_f32 v184, v36, v37
    v_cvt_pk_bf16_f32 v185, v38, v39
    v_lshlrev_b32 v36, 16, v186
    v_and_b32 v37, s95, v186
    v_lshlrev_b32 v38, 16, v187
    v_and_b32 v39, s95, v187
    v_mul_f32 v36, s88, v36
    v_mul_f32 v37, s88, v37
    v_mul_f32 v38, s88, v38
    v_mul_f32 v39, s88, v39
    v_cvt_pk_bf16_f32 v186, v36, v37
    v_cvt_pk_bf16_f32 v187, v38, v39
    v_lshlrev_b32 v36, 16, v188
    v_and_b32 v37, s95, v188
    v_lshlrev_b32 v38, 16, v189
    v_and_b32 v39, s95, v189
    v_mul_f32 v36, s88, v36
    v_mul_f32 v37, s88, v37
    v_mul_f32 v38, s88, v38
    v_mul_f32 v39, s88, v39
    v_cvt_pk_bf16_f32 v188, v36, v37
    v_cvt_pk_bf16_f32 v189, v38, v39
    v_lshlrev_b32 v36, 16, v190
    v_and_b32 v37, s95, v190
    v_lshlrev_b32 v38, 16, v191
    v_and_b32 v39, s95, v191
    v_mul_f32 v36, s88, v36
    v_mul_f32 v37, s88, v37
    v_mul_f32 v38, s88, v38
    v_mul_f32 v39, s88, v39
    v_cvt_pk_bf16_f32 v190, v36, v37
    v_cvt_pk_bf16_f32 v191, v38, v39
    s_add_u32 m0, s58, 49152
    s_nop 0
    buffer_load_dwordx4 v14, s[28:31], s56 offen offset:0  lds
    buffer_load_dwordx4 v15, s[28:31], s56 offen offset:1024  lds
    buffer_load_dwordx4 v14, s[28:31], s56 offen offset:2048  lds
    buffer_load_dwordx4 v15, s[28:31], s56 offen offset:3072  lds
    s_mov_b32 s55, 16384
    s_add_u32 m0, s58, 16384
    s_nop 0
    buffer_load_dwordx4 v14, s[24:27], s55 offen offset:0  lds
    buffer_load_dwordx4 v15, s[24:27], s55 offen offset:1024  lds
    buffer_load_dwordx4 v14, s[24:27], s55 offen offset:2048  lds
    buffer_load_dwordx4 v15, s[24:27], s55 offen offset:3072  lds
    s_mov_b32 s55, 32768
    s_mov_b32 s56, 16384
    s_waitcnt vmcnt(12)
    ds_read_b128 v[192:195], v21 offset:8192
    ds_read_b128 v[196:199], v22 offset:8192
    ds_read_b128 v[200:203], v23 offset:8192
    ds_read_b128 v[204:207], v24 offset:8192
    s_waitcnt lgkmcnt(0)
    v_lshlrev_b32 v36, 16, v192
    v_and_b32 v37, s95, v192
    v_lshlrev_b32 v38, 16, v193
    v_and_b32 v39, s95, v193
    v_mul_f32 v36, s88, v36
    v_mul_f32 v37, s88, v37
    v_mul_f32 v38, s88, v38
    v_mul_f32 v39, s88, v39
    v_cvt_pk_bf16_f32 v192, v36, v37
    v_cvt_pk_bf16_f32 v193, v38, v39
    v_lshlrev_b32 v36, 16, v194
    v_and_b32 v37, s95, v194
    v_lshlrev_b32 v38, 16, v195
    v_and_b32 v39, s95, v195
    v_mul_f32 v36, s88, v36
    v_mul_f32 v37, s88, v37
    v_mul_f32 v38, s88, v38
    v_mul_f32 v39, s88, v39
    v_cvt_pk_bf16_f32 v194, v36, v37
    v_cvt_pk_bf16_f32 v195, v38, v39
    v_lshlrev_b32 v36, 16, v196
    v_and_b32 v37, s95, v196
    v_lshlrev_b32 v38, 16, v197
    v_and_b32 v39, s95, v197
    v_mul_f32 v36, s88, v36
    v_mul_f32 v37, s88, v37
    v_mul_f32 v38, s88, v38
    v_mul_f32 v39, s88, v39
    v_cvt_pk_bf16_f32 v196, v36, v37
    v_cvt_pk_bf16_f32 v197, v38, v39
    v_lshlrev_b32 v36, 16, v198
    v_and_b32 v37, s95, v198
    v_lshlrev_b32 v38, 16, v199
    v_and_b32 v39, s95, v199
    v_mul_f32 v36, s88, v36
    v_mul_f32 v37, s88, v37
    v_mul_f32 v38, s88, v38
    v_mul_f32 v39, s88, v39
    v_cvt_pk_bf16_f32 v198, v36, v37
    v_cvt_pk_bf16_f32 v199, v38, v39
    v_lshlrev_b32 v36, 16, v200
    v_and_b32 v37, s95, v200
    v_lshlrev_b32 v38, 16, v201
    v_and_b32 v39, s95, v201
    v_mul_f32 v36, s88, v36
    v_mul_f32 v37, s88, v37
    v_mul_f32 v38, s88, v38
    v_mul_f32 v39, s88, v39
    v_cvt_pk_bf16_f32 v200, v36, v37
    v_cvt_pk_bf16_f32 v201, v38, v39
    v_lshlrev_b32 v36, 16, v202
    v_and_b32 v37, s95, v202
    v_lshlrev_b32 v38, 16, v203
    v_and_b32 v39, s95, v203
    v_mul_f32 v36, s88, v36
    v_mul_f32 v37, s88, v37
    v_mul_f32 v38, s88, v38
    v_mul_f32 v39, s88, v39
    v_cvt_pk_bf16_f32 v202, v36, v37
    v_cvt_pk_bf16_f32 v203, v38, v39
    v_lshlrev_b32 v36, 16, v204
    v_and_b32 v37, s95, v204
    v_lshlrev_b32 v38, 16, v205
    v_and_b32 v39, s95, v205
    v_mul_f32 v36, s88, v36
    v_mul_f32 v37, s88, v37
    v_mul_f32 v38, s88, v38
    v_mul_f32 v39, s88, v39
    v_cvt_pk_bf16_f32 v204, v36, v37
    v_cvt_pk_bf16_f32 v205, v38, v39
    v_lshlrev_b32 v36, 16, v206
    v_and_b32 v37, s95, v206
    v_lshlrev_b32 v38, 16, v207
    v_and_b32 v39, s95, v207
    v_mul_f32 v36, s88, v36
    v_mul_f32 v37, s88, v37
    v_mul_f32 v38, s88, v38
    v_mul_f32 v39, s88, v39
    v_cvt_pk_bf16_f32 v206, v36, v37
    v_cvt_pk_bf16_f32 v207, v38, v39
    s_waitcnt vmcnt(8)
    ds_read_b128 v[208:211], v21 offset:12288
    ds_read_b128 v[212:215], v22 offset:12288
    ds_read_b128 v[216:219], v23 offset:12288
    ds_read_b128 v[220:223], v24 offset:12288
    s_waitcnt lgkmcnt(0)
    v_lshlrev_b32 v36, 16, v208
    v_and_b32 v37, s95, v208
    v_lshlrev_b32 v38, 16, v209
    v_and_b32 v39, s95, v209
    v_mul_f32 v36, s88, v36
    v_mul_f32 v37, s88, v37
    v_mul_f32 v38, s88, v38
    v_mul_f32 v39, s88, v39
    v_cvt_pk_bf16_f32 v208, v36, v37
    v_cvt_pk_bf16_f32 v209, v38, v39
    v_lshlrev_b32 v36, 16, v210
    v_and_b32 v37, s95, v210
    v_lshlrev_b32 v38, 16, v211
    v_and_b32 v39, s95, v211
    v_mul_f32 v36, s88, v36
    v_mul_f32 v37, s88, v37
    v_mul_f32 v38, s88, v38
    v_mul_f32 v39, s88, v39
    v_cvt_pk_bf16_f32 v210, v36, v37
    v_cvt_pk_bf16_f32 v211, v38, v39
    v_lshlrev_b32 v36, 16, v212
    v_and_b32 v37, s95, v212
    v_lshlrev_b32 v38, 16, v213
    v_and_b32 v39, s95, v213
    v_mul_f32 v36, s88, v36
    v_mul_f32 v37, s88, v37
    v_mul_f32 v38, s88, v38
    v_mul_f32 v39, s88, v39
    v_cvt_pk_bf16_f32 v212, v36, v37
    v_cvt_pk_bf16_f32 v213, v38, v39
    v_lshlrev_b32 v36, 16, v214
    v_and_b32 v37, s95, v214
    v_lshlrev_b32 v38, 16, v215
    v_and_b32 v39, s95, v215
    v_mul_f32 v36, s88, v36
    v_mul_f32 v37, s88, v37
    v_mul_f32 v38, s88, v38
    v_mul_f32 v39, s88, v39
    v_cvt_pk_bf16_f32 v214, v36, v37
    v_cvt_pk_bf16_f32 v215, v38, v39
    v_lshlrev_b32 v36, 16, v216
    v_and_b32 v37, s95, v216
    v_lshlrev_b32 v38, 16, v217
    v_and_b32 v39, s95, v217
    v_mul_f32 v36, s88, v36
    v_mul_f32 v37, s88, v37
    v_mul_f32 v38, s88, v38
    v_mul_f32 v39, s88, v39
    v_cvt_pk_bf16_f32 v216, v36, v37
    v_cvt_pk_bf16_f32 v217, v38, v39
    v_lshlrev_b32 v36, 16, v218
    v_and_b32 v37, s95, v218
    v_lshlrev_b32 v38, 16, v219
    v_and_b32 v39, s95, v219
    v_mul_f32 v36, s88, v36
    v_mul_f32 v37, s88, v37
    v_mul_f32 v38, s88, v38
    v_mul_f32 v39, s88, v39
    v_cvt_pk_bf16_f32 v218, v36, v37
    v_cvt_pk_bf16_f32 v219, v38, v39
    v_lshlrev_b32 v36, 16, v220
    v_and_b32 v37, s95, v220
    v_lshlrev_b32 v38, 16, v221
    v_and_b32 v39, s95, v221
    v_mul_f32 v36, s88, v36
    v_mul_f32 v37, s88, v37
    v_mul_f32 v38, s88, v38
    v_mul_f32 v39, s88, v39
    v_cvt_pk_bf16_f32 v220, v36, v37
    v_cvt_pk_bf16_f32 v221, v38, v39
    v_lshlrev_b32 v36, 16, v222
    v_and_b32 v37, s95, v222
    v_lshlrev_b32 v38, 16, v223
    v_and_b32 v39, s95, v223
    v_mul_f32 v36, s88, v36
    v_mul_f32 v37, s88, v37
    v_mul_f32 v38, s88, v38
    v_mul_f32 v39, s88, v39
    v_cvt_pk_bf16_f32 v222, v36, v37
    v_cvt_pk_bf16_f32 v223, v38, v39
    s_barrier
    ds_read_b128 a[128:131], v2 offset:0
    ds_read_b128 a[132:135], v3 offset:0
    ds_read_b128 a[136:139], v4 offset:0
    ds_read_b128 a[140:143], v5 offset:0
    s_mov_b32 s57, -2
    s_waitcnt lgkmcnt(0)
    v_mfma_f32_16x16x32_bf16 v[32:35], a[128:131], v[160:163], 0
    s_add_u32 s57, s57, 1
    v_mfma_f32_16x16x32_bf16 v[32:35], a[132:135], v[164:167], v[32:35]
    s_add_u32 m0, s58, 32768
    ds_read_b128 a[144:147], v2 offset:4096
    ds_read_b128 a[148:151], v3 offset:4096
    v_mfma_f32_16x16x32_bf16 v[32:35], a[136:139], v[168:171], v[32:35]
    buffer_load_dwordx4 v14, s[24:27], s55 offen offset:0  lds
    v_mfma_f32_16x16x32_bf16 v[32:35], a[140:143], v[172:175], v[32:35]
    v_mfma_f32_16x16x32_bf16 v[36:39], a[128:131], v[176:179], 0
    v_mfma_f32_16x16x32_bf16 v[36:39], a[132:135], v[180:183], v[36:39]
    ds_read_b128 a[152:155], v4 offset:4096
    ds_read_b128 a[156:159], v5 offset:4096
    v_mfma_f32_16x16x32_bf16 v[36:39], a[136:139], v[184:187], v[36:39]
    buffer_load_dwordx4 v15, s[24:27], s55 offen offset:1024  lds
    v_mfma_f32_16x16x32_bf16 v[36:39], a[140:143], v[188:191], v[36:39]
    v_mfma_f32_16x16x32_bf16 v[40:43], a[128:131], v[192:195], 0
    v_exp_f32 v32, v32
    v_mfma_f32_16x16x32_bf16 v[40:43], a[132:135], v[196:199], v[40:43]
    v_mfma_f32_16x16x32_bf16 v[40:43], a[136:139], v[200:203], v[40:43]
    buffer_load_dwordx4 v14, s[24:27], s55 offen offset:2048  lds
    v_mfma_f32_16x16x32_bf16 v[40:43], a[140:143], v[204:207], v[40:43]
    v_exp_f32 v33, v33
    v_mfma_f32_16x16x32_bf16 v[44:47], a[128:131], v[208:211], 0
    v_exp_f32 v34, v34
    v_mfma_f32_16x16x32_bf16 v[44:47], a[132:135], v[212:215], v[44:47]
    v_mfma_f32_16x16x32_bf16 v[44:47], a[136:139], v[216:219], v[44:47]
    buffer_load_dwordx4 v15, s[24:27], s55 offen offset:3072  lds
    v_mfma_f32_16x16x32_bf16 v[44:47], a[140:143], v[220:223], v[44:47]
    s_waitcnt lgkmcnt(0)
    v_cvt_pk_bf16_f32 v96, v32, v33
    v_mfma_f32_16x16x32_bf16 v[48:51], a[144:147], v[160:163], 0
    v_exp_f32 v35, v35
    v_mfma_f32_16x16x32_bf16 v[48:51], a[148:151], v[164:167], v[48:51]
    s_mov_b32 s60, 49152
    s_mov_b32 m0, 160768
    ds_read_b128 a[128:131], v2 offset:8192
    ds_read_b128 a[132:135], v3 offset:8192
    v_mfma_f32_16x16x32_bf16 v[48:51], a[152:155], v[168:171], v[48:51]
    buffer_load_dwordx4 v249, s[24:27], s60 offen  lds
    v_mfma_f32_16x16x32_bf16 v[48:51], a[156:159], v[172:175], v[48:51]
    v_exp_f32 v36, v36
    v_mfma_f32_16x16x32_bf16 v[52:55], a[144:147], v[176:179], 0
    v_exp_f32 v37, v37
    v_mfma_f32_16x16x32_bf16 v[52:55], a[148:151], v[180:183], v[52:55]
    s_mov_b32 s60, 16384
    s_mov_b32 m0, 160768
    ds_read_b128 a[136:139], v4 offset:8192
    ds_read_b128 a[140:143], v5 offset:8192
    v_mfma_f32_16x16x32_bf16 v[52:55], a[152:155], v[184:187], v[52:55]
    buffer_load_dwordx4 v249, s[28:31], s60 offen  lds
    v_mfma_f32_16x16x32_bf16 v[52:55], a[156:159], v[188:191], v[52:55]
    v_cvt_pk_bf16_f32 v97, v34, v35
    v_cvt_pk_bf16_f32 v104, v36, v37
    v_mfma_f32_16x16x32_bf16 v[56:59], a[144:147], v[192:195], 0
    v_exp_f32 v38, v38
    v_mfma_f32_16x16x32_bf16 v[56:59], a[148:151], v[196:199], v[56:59]
    s_add_u32 s99, s98, 0
    v_mfma_f32_16x16x32_bf16 v[56:59], a[152:155], v[200:203], v[56:59]
    buffer_load_dwordx4 a[204:207], v246, s[4:7], s99 offen nt
    v_mfma_f32_16x16x32_bf16 v[56:59], a[156:159], v[204:207], v[56:59]
    v_exp_f32 v39, v39
    v_mfma_f32_16x16x32_bf16 v[60:63], a[144:147], v[208:211], 0
    v_exp_f32 v40, v40
    v_mfma_f32_16x16x32_bf16 v[60:63], a[148:151], v[212:215], v[60:63]
    s_add_u32 s99, s98, 4096
    v_mfma_f32_16x16x32_bf16 v[60:63], a[152:155], v[216:219], v[60:63]
    buffer_load_dwordx4 a[208:211], v246, s[4:7], s99 offen nt
    v_mfma_f32_16x16x32_bf16 v[60:63], a[156:159], v[220:223], v[60:63]
    s_waitcnt lgkmcnt(0)
    v_exp_f32 v41, v41
    v_mfma_f32_16x16x32_bf16 v[64:67], a[128:131], v[160:163], 0
    v_cvt_pk_bf16_f32 v105, v38, v39
    v_cvt_pk_bf16_f32 v112, v40, v41
    v_mfma_f32_16x16x32_bf16 v[64:67], a[132:135], v[164:167], v[64:67]
    s_add_u32 s99, s98, 8192
    ds_read_b128 a[144:147], v2 offset:12288
    ds_read_b128 a[148:151], v3 offset:12288
    v_mfma_f32_16x16x32_bf16 v[64:67], a[136:139], v[168:171], v[64:67]
    buffer_load_dwordx4 a[212:215], v246, s[4:7], s99 offen nt
    v_mfma_f32_16x16x32_bf16 v[64:67], a[140:143], v[172:175], v[64:67]
    v_exp_f32 v42, v42
    v_mfma_f32_16x16x32_bf16 v[68:71], a[128:131], v[176:179], 0
    v_exp_f32 v43, v43
    v_mfma_f32_16x16x32_bf16 v[68:71], a[132:135], v[180:183], v[68:71]
    s_add_u32 s99, s98, 12288
    ds_read_b128 a[152:155], v4 offset:12288
    ds_read_b128 a[156:159], v5 offset:12288
    v_mfma_f32_16x16x32_bf16 v[68:71], a[136:139], v[184:187], v[68:71]
    s_sub_u32 s93, s91, s90
    buffer_load_dwordx4 a[216:219], v246, s[4:7], s99 offen nt
    v_mfma_f32_16x16x32_bf16 v[68:71], a[140:143], v[188:191], v[68:71]
    v_exp_f32 v44, v44
    v_mfma_f32_16x16x32_bf16 v[72:75], a[128:131], v[192:195], 0
    s_mov_b32 s60, s90
    s_mov_b32 s90, s91
    s_mov_b32 s91, s92
    s_mov_b32 s92, s60
    v_exp_f32 v45, v45
    v_mfma_f32_16x16x32_bf16 v[72:75], a[132:135], v[196:199], v[72:75]
    s_add_u32 s99, s98, 16384
    v_add_u32 v2, s93, v2
    v_add_u32 v3, s93, v3
    v_mfma_f32_16x16x32_bf16 v[72:75], a[136:139], v[200:203], v[72:75]
    buffer_load_dwordx4 a[220:223], v246, s[4:7], s99 offen nt
    v_mfma_f32_16x16x32_bf16 v[72:75], a[140:143], v[204:207], v[72:75]
    v_add_u32 v4, s93, v4
    v_add_u32 v5, s93, v5
    v_mfma_f32_16x16x32_bf16 v[76:79], a[128:131], v[208:211], 0
    v_exp_f32 v46, v46
    v_mfma_f32_16x16x32_bf16 v[76:79], a[132:135], v[212:215], v[76:79]
    s_add_u32 s99, s98, 20480
    v_mfma_f32_16x16x32_bf16 v[76:79], a[136:139], v[216:219], v[76:79]
    buffer_load_dwordx4 a[224:227], v246, s[4:7], s99 offen nt
    v_mfma_f32_16x16x32_bf16 v[76:79], a[140:143], v[220:223], v[76:79]
    s_waitcnt lgkmcnt(0)
    v_exp_f32 v47, v47
    v_mfma_f32_16x16x32_bf16 v[80:83], a[144:147], v[160:163], 0
    v_exp_f32 v48, v48
    v_mfma_f32_16x16x32_bf16 v[80:83], a[148:151], v[164:167], v[80:83]
    s_add_u32 s99, s98, 24576
    v_mfma_f32_16x16x32_bf16 v[80:83], a[152:155], v[168:171], v[80:83]
    buffer_load_dwordx4 a[228:231], v246, s[4:7], s99 offen nt
    v_mfma_f32_16x16x32_bf16 v[80:83], a[156:159], v[172:175], v[80:83]
    v_cvt_pk_bf16_f32 v113, v42, v43
    v_cvt_pk_bf16_f32 v120, v44, v45
    v_mfma_f32_16x16x32_bf16 v[84:87], a[144:147], v[176:179], 0
    v_exp_f32 v49, v49
    v_mfma_f32_16x16x32_bf16 v[84:87], a[148:151], v[180:183], v[84:87]
    s_add_u32 s99, s98, 28672
    v_mfma_f32_16x16x32_bf16 v[84:87], a[152:155], v[184:187], v[84:87]
    buffer_load_dwordx4 a[232:235], v246, s[4:7], s99 offen nt
    v_mfma_f32_16x16x32_bf16 v[84:87], a[156:159], v[188:191], v[84:87]
    v_exp_f32 v50, v50
    v_mfma_f32_16x16x32_bf16 v[88:91], a[144:147], v[192:195], 0
    v_exp_f32 v51, v51
    v_mfma_f32_16x16x32_bf16 v[88:91], a[148:151], v[196:199], v[88:91]
    v_mfma_f32_16x16x32_bf16 v[88:91], a[152:155], v[200:203], v[88:91]
    v_mfma_f32_16x16x32_bf16 v[88:91], a[156:159], v[204:207], v[88:91]
    v_exp_f32 v52, v52
    v_mfma_f32_16x16x32_bf16 v[92:95], a[144:147], v[208:211], 0
    v_cvt_pk_bf16_f32 v121, v46, v47
    v_cvt_pk_bf16_f32 v98, v48, v49
    v_mfma_f32_16x16x32_bf16 v[92:95], a[148:151], v[212:215], v[92:95]
    v_mfma_f32_16x16x32_bf16 v[92:95], a[152:155], v[216:219], v[92:95]
    v_mfma_f32_16x16x32_bf16 v[92:95], a[156:159], v[220:223], v[92:95]
    v_exp_f32 v53, v53
    v_exp_f32 v54, v54
    v_exp_f32 v55, v55
    v_exp_f32 v56, v56
    v_cvt_pk_bf16_f32 v99, v50, v51
    v_cvt_pk_bf16_f32 v106, v52, v53
    v_exp_f32 v57, v57
    v_exp_f32 v58, v58
    v_exp_f32 v59, v59
    v_exp_f32 v60, v60
    v_exp_f32 v61, v61
    v_cvt_pk_bf16_f32 v107, v54, v55
    v_cvt_pk_bf16_f32 v114, v56, v57
    v_exp_f32 v62, v62
    v_cvt_pk_bf16_f32 v115, v58, v59
    v_cvt_pk_bf16_f32 v122, v60, v61
    v_exp_f32 v63, v63
    v_exp_f32 v64, v64
    v_exp_f32 v65, v65
    v_exp_f32 v66, v66
    v_cvt_pk_bf16_f32 v123, v62, v63
    v_cvt_pk_bf16_f32 v100, v64, v65
    v_exp_f32 v67, v67
    v_exp_f32 v68, v68
    v_exp_f32 v69, v69
    v_exp_f32 v70, v70
    v_cvt_pk_bf16_f32 v101, v66, v67
    v_cvt_pk_bf16_f32 v108, v68, v69
    v_exp_f32 v71, v71
    v_exp_f32 v72, v72
    v_cvt_pk_bf16_f32 v109, v70, v71
    v_exp_f32 v73, v73
    v_exp_f32 v74, v74
    v_exp_f32 v75, v75
    v_exp_f32 v76, v76
    v_exp_f32 v77, v77
    v_exp_f32 v78, v78
    v_exp_f32 v79, v79
    v_exp_f32 v80, v80
    v_exp_f32 v81, v81
    v_exp_f32 v82, v82
    v_add_u32 v248, 1, v248
    v_cvt_pk_bf16_f32 v116, v72, v73
    v_exp_f32 v83, v83
    v_exp_f32 v84, v84
    s_waitcnt vmcnt(10) lgkmcnt(0)
    s_barrier
    ds_write_b32 v255, v248
    v_cvt_pk_bf16_f32 v117, v74, v75
    ds_read_b128 a[128:131], v2 offset:0
    v_cvt_pk_bf16_f32 v124, v76, v77
    v_cvt_pk_bf16_f32 v125, v78, v79
    ds_read_b128 a[132:135], v3 offset:0
    v_exp_f32 v85, v85
    ds_read_b128 a[136:139], v4 offset:0
    v_exp_f32 v86, v86
    ds_read_b128 a[140:143], v5 offset:0
    v_cvt_pk_bf16_f32 v102, v80, v81
    v_cvt_pk_bf16_f32 v103, v82, v83
    v_exp_f32 v87, v87
    v_cvt_pk_bf16_f32 v110, v84, v85
    v_cvt_pk_bf16_f32 v111, v86, v87
    v_exp_f32 v88, v88
    v_exp_f32 v89, v89
    s_nop 0
    v_cvt_pk_bf16_f32 v118, v88, v89
    v_exp_f32 v90, v90
    v_exp_f32 v91, v91
    v_exp_f32 v92, v92
    s_mov_b32 s55, 49152
.p2align 6
L_loop_standalone__tree_speculative_verify_tree_attention_over_candidate_token_tree__prompt_kernel:
    s_waitcnt lgkmcnt(0)
    v_mfma_f32_16x16x32_bf16 v[32:35], a[128:131], v[160:163], 0
    s_add_u32 s57, s57, 1
    v_exp_f32 v93, v93
    v_mfma_f32_16x16x32_bf16 v[32:35], a[132:135], v[164:167], v[32:35]
    ds_read_b128 a[144:147], v2 offset:4096
    ds_read_b128 a[148:151], v3 offset:4096
    v_mfma_f32_16x16x32_bf16 v[32:35], a[136:139], v[168:171], v[32:35]
    v_mfma_f32_16x16x32_bf16 v[32:35], a[140:143], v[172:175], v[32:35]
    v_exp_f32 v94, v94
    v_mfma_f32_16x16x32_bf16 v[36:39], a[128:131], v[176:179], 0
    v_cvt_pk_bf16_f32 v119, v90, v91
    v_cvt_pk_bf16_f32 v126, v92, v93
    v_mfma_f32_16x16x32_bf16 v[36:39], a[132:135], v[180:183], v[36:39]
    ds_read_b128 a[152:155], v4 offset:4096
    ds_read_b128 a[156:159], v5 offset:4096
    v_mfma_f32_16x16x32_bf16 v[36:39], a[136:139], v[184:187], v[36:39]
    v_mfma_f32_16x16x32_bf16 v[36:39], a[140:143], v[188:191], v[36:39]
    v_exp_f32 v95, v95
    v_mfma_f32_16x16x32_bf16 v[40:43], a[128:131], v[192:195], 0
    v_exp_f32 v32, v32
    v_mfma_f32_16x16x32_bf16 v[40:43], a[132:135], v[196:199], v[40:43]
    v_mfma_f32_16x16x32_bf16 v[40:43], a[136:139], v[200:203], v[40:43]
    v_mfma_f32_16x16x32_bf16 v[40:43], a[140:143], v[204:207], v[40:43]
    v_exp_f32 v33, v33
    v_mfma_f32_16x16x32_bf16 v[44:47], a[128:131], v[208:211], 0
    v_exp_f32 v34, v34
    v_mfma_f32_16x16x32_bf16 v[44:47], a[132:135], v[212:215], v[44:47]
    v_mfma_f32_16x16x32_bf16 v[44:47], a[136:139], v[216:219], v[44:47]
    v_mfma_f32_16x16x32_bf16 v[44:47], a[140:143], v[220:223], v[44:47]
    s_waitcnt lgkmcnt(0)
    v_cvt_pk_bf16_f32 v128, v32, v33
    v_cvt_pk_bf16_f32 v127, v94, v95
    v_mfma_f32_16x16x32_bf16 v[48:51], a[144:147], v[160:163], 0
    v_exp_f32 v35, v35
    v_mfma_f32_16x16x32_bf16 v[48:51], a[148:151], v[164:167], v[48:51]
    ds_read_b32 v252, v253
    ds_read_b128 a[128:131], v2 offset:8192
    v_mfma_f32_16x16x32_bf16 v[48:51], a[152:155], v[168:171], v[48:51]
    v_mfma_f32_16x16x32_bf16 v[48:51], a[156:159], v[172:175], v[48:51]
    v_exp_f32 v36, v36
    v_mfma_f32_16x16x32_bf16 v[52:55], a[144:147], v[176:179], 0
    v_exp_f32 v37, v37
    v_mfma_f32_16x16x32_bf16 v[52:55], a[148:151], v[180:183], v[52:55]
    ds_read_b128 a[132:135], v3 offset:8192
    ds_read_b128 a[136:139], v4 offset:8192
    v_mfma_f32_16x16x32_bf16 v[52:55], a[152:155], v[184:187], v[52:55]
    v_mfma_f32_16x16x32_bf16 v[52:55], a[156:159], v[188:191], v[52:55]
    v_cvt_pk_bf16_f32 v129, v34, v35
    v_cvt_pk_bf16_f32 v136, v36, v37
    v_mfma_f32_16x16x32_bf16 v[56:59], a[144:147], v[192:195], 0
    v_exp_f32 v38, v38
    v_mfma_f32_16x16x32_bf16 v[56:59], a[148:151], v[196:199], v[56:59]
    ds_read_b128 a[140:143], v5 offset:8192
    v_mfma_f32_16x16x32_bf16 v[56:59], a[152:155], v[200:203], v[56:59]
    v_mfma_f32_16x16x32_bf16 v[56:59], a[156:159], v[204:207], v[56:59]
    v_exp_f32 v39, v39
    v_mfma_f32_16x16x32_bf16 v[60:63], a[144:147], v[208:211], 0
    v_exp_f32 v40, v40
    v_mfma_f32_16x16x32_bf16 v[60:63], a[148:151], v[212:215], v[60:63]
    s_waitcnt lgkmcnt(4)
    v_cmp_gt_u32 vcc, v248, v252
    v_mfma_f32_16x16x32_bf16 v[60:63], a[152:155], v[216:219], v[60:63]
    s_cbranch_vccnz L_spina_standalone__tree_speculative_verify_tree_attention_over_candidate_token_tree__prompt_kernel
L_spinra_standalone__tree_speculative_verify_tree_attention_over_candidate_token_tree__prompt_kernel:
    v_mfma_f32_16x16x32_bf16 v[60:63], a[156:159], v[220:223], v[60:63]
    s_waitcnt lgkmcnt(0)
    v_exp_f32 v41, v41
    v_mfma_f32_16x16x32_bf16 v[64:67], a[128:131], v[160:163], 0
    v_cvt_pk_bf16_f32 v137, v38, v39
    v_cvt_pk_bf16_f32 v144, v40, v41
    v_mfma_f32_16x16x32_bf16 v[64:67], a[132:135], v[164:167], v[64:67]
    s_add_u32 m0, s58, s92
    ds_read_b128 a[144:147], v2 offset:12288
    ds_read_b128 a[148:151], v3 offset:12288
    v_mfma_f32_16x16x32_bf16 v[64:67], a[136:139], v[168:171], v[64:67]
    buffer_load_dwordx4 v14, s[24:27], s55 offen offset:0  lds
    v_mfma_f32_16x16x32_bf16 v[64:67], a[140:143], v[172:175], v[64:67]
    v_exp_f32 v42, v42
    v_mfma_f32_16x16x32_bf16 v[68:71], a[128:131], v[176:179], 0
    v_exp_f32 v43, v43
    v_mfma_f32_16x16x32_bf16 v[68:71], a[132:135], v[180:183], v[68:71]
    ds_read_b128 a[152:155], v4 offset:12288
    ds_read_b128 a[156:159], v5 offset:12288
    v_mfma_f32_16x16x32_bf16 v[68:71], a[136:139], v[184:187], v[68:71]
    s_sub_u32 s93, s91, s90
    buffer_load_dwordx4 v15, s[24:27], s55 offen offset:1024  lds
    v_mfma_f32_16x16x32_bf16 v[68:71], a[140:143], v[188:191], v[68:71]
    v_exp_f32 v44, v44
    v_mfma_f32_16x16x32_bf16 v[72:75], a[128:131], v[192:195], 0
    s_mov_b32 s60, s90
    s_mov_b32 s90, s91
    s_mov_b32 s91, s92
    s_mov_b32 s92, s60
    v_exp_f32 v45, v45
    v_mfma_f32_16x16x32_bf16 v[72:75], a[132:135], v[196:199], v[72:75]
    v_add_u32 v2, s93, v2
    v_add_u32 v3, s93, v3
    v_mfma_f32_16x16x32_bf16 v[72:75], a[136:139], v[200:203], v[72:75]
    buffer_load_dwordx4 v14, s[24:27], s55 offen offset:2048  lds
    v_mfma_f32_16x16x32_bf16 v[72:75], a[140:143], v[204:207], v[72:75]
    v_add_u32 v4, s93, v4
    v_add_u32 v5, s93, v5
    v_mfma_f32_16x16x32_bf16 v[76:79], a[128:131], v[208:211], 0
    v_exp_f32 v46, v46
    v_mfma_f32_16x16x32_bf16 v[76:79], a[132:135], v[212:215], v[76:79]
    v_mfma_f32_16x16x32_bf16 v[76:79], a[136:139], v[216:219], v[76:79]
    buffer_load_dwordx4 v15, s[24:27], s55 offen offset:3072  lds
    v_mfma_f32_16x16x32_bf16 v[76:79], a[140:143], v[220:223], v[76:79]
    s_waitcnt lgkmcnt(0)
    v_exp_f32 v47, v47
    v_mfma_f32_16x16x32_bf16 v[80:83], a[144:147], v[160:163], 0
    v_exp_f32 v48, v48
    v_mfma_f32_16x16x32_bf16 v[80:83], a[148:151], v[164:167], v[80:83]
    s_add_u32 m0, s58, 65536
    ds_read_b64_tr_b16 a[160:161], v6 offset:0
    ds_read_b64_tr_b16 a[162:163], v6 offset:4096
    v_mfma_f32_16x16x32_bf16 v[80:83], a[152:155], v[168:171], v[80:83]
    buffer_load_dwordx4 v14, s[28:31], s56 offen offset:0  lds
    v_mfma_f32_16x16x32_bf16 v[80:83], a[156:159], v[172:175], v[80:83]
    v_cvt_pk_bf16_f32 v145, v42, v43
    v_cvt_pk_bf16_f32 v152, v44, v45
    v_mfma_f32_16x16x32_bf16 v[84:87], a[144:147], v[176:179], 0
    v_exp_f32 v49, v49
    v_mfma_f32_16x16x32_bf16 v[84:87], a[148:151], v[180:183], v[84:87]
    ds_read_b64_tr_b16 a[164:165], v6 offset:8192
    ds_read_b64_tr_b16 a[166:167], v6 offset:12288
    v_mfma_f32_16x16x32_bf16 v[84:87], a[152:155], v[184:187], v[84:87]
    buffer_load_dwordx4 v15, s[28:31], s56 offen offset:1024  lds
    v_mfma_f32_16x16x32_bf16 v[84:87], a[156:159], v[188:191], v[84:87]
    v_exp_f32 v50, v50
    v_mfma_f32_16x16x32_bf16 v[88:91], a[144:147], v[192:195], 0
    v_exp_f32 v51, v51
    v_mfma_f32_16x16x32_bf16 v[88:91], a[148:151], v[196:199], v[88:91]
    ds_read_b64_tr_b16 a[168:169], v7 offset:0
    ds_read_b64_tr_b16 a[170:171], v7 offset:4096
    v_mfma_f32_16x16x32_bf16 v[88:91], a[152:155], v[200:203], v[88:91]
    buffer_load_dwordx4 v14, s[28:31], s56 offen offset:2048  lds
    v_mfma_f32_16x16x32_bf16 v[88:91], a[156:159], v[204:207], v[88:91]
    v_exp_f32 v52, v52
    v_mfma_f32_16x16x32_bf16 v[92:95], a[144:147], v[208:211], 0
    v_cvt_pk_bf16_f32 v153, v46, v47
    v_cvt_pk_bf16_f32 v130, v48, v49
    v_mfma_f32_16x16x32_bf16 v[92:95], a[148:151], v[212:215], v[92:95]
    ds_read_b64_tr_b16 a[172:173], v7 offset:8192
    ds_read_b64_tr_b16 a[174:175], v7 offset:12288
    v_mfma_f32_16x16x32_bf16 v[92:95], a[152:155], v[216:219], v[92:95]
    buffer_load_dwordx4 v15, s[28:31], s56 offen offset:3072  lds
    v_mfma_f32_16x16x32_bf16 v[92:95], a[156:159], v[220:223], v[92:95]
    s_add_u32 s55, s55, 16384
    s_min_u32 s55, s55, 507904
    s_waitcnt lgkmcnt(4)
    v_exp_f32 v53, v53
    v_mfma_f32_16x16x32_bf16 a[0:3], a[160:163], v[96:99], a[0:3]
    s_add_u32 s56, s56, 16384
    v_exp_f32 v54, v54
    v_mfma_f32_16x16x32_bf16 a[0:3], a[164:167], v[100:103], a[0:3]
    s_mov_b32 m0, 160768
    ds_read_b64_tr_b16 a[176:177], v8 offset:0
    ds_read_b64_tr_b16 a[178:179], v8 offset:4096
    v_mfma_f32_16x16x32_bf16 a[4:7], a[160:163], v[104:107], a[4:7]
    buffer_load_dwordx4 v249, s[24:27], s68 offen  lds
    v_mfma_f32_16x16x32_bf16 a[4:7], a[164:167], v[108:111], a[4:7]
    v_exp_f32 v55, v55
    v_mfma_f32_16x16x32_bf16 a[8:11], a[160:163], v[112:115], a[8:11]
    buffer_load_dwordx4 v246, s[40:43], s69 offen  lds
    v_mfma_f32_16x16x32_bf16 a[8:11], a[164:167], v[116:119], a[8:11]
    ds_read_b64_tr_b16 a[180:181], v8 offset:8192
    ds_read_b64_tr_b16 a[182:183], v8 offset:12288
    v_mfma_f32_16x16x32_bf16 a[12:15], a[160:163], v[120:123], a[12:15]
    v_exp_f32 v56, v56
    v_mfma_f32_16x16x32_bf16 a[12:15], a[164:167], v[124:127], a[12:15]
    v_cvt_pk_bf16_f32 v131, v50, v51
    v_cvt_pk_bf16_f32 v138, v52, v53
    v_smfmac_f32_16x16x64_bf16 a[184:187], a[200:203], v[96:103], v18
    s_waitcnt lgkmcnt(4)
    v_exp_f32 v57, v57
    v_mfma_f32_16x16x32_bf16 a[16:19], a[168:171], v[96:99], a[16:19]
    v_exp_f32 v58, v58
    v_mfma_f32_16x16x32_bf16 a[16:19], a[172:175], v[100:103], a[16:19]
    ds_read_b64_tr_b16 a[160:161], v9 offset:0
    ds_read_b64_tr_b16 a[162:163], v9 offset:4096
    v_mfma_f32_16x16x32_bf16 a[20:23], a[168:171], v[104:107], a[20:23]
    v_exp_f32 v59, v59
    v_mfma_f32_16x16x32_bf16 a[20:23], a[172:175], v[108:111], a[20:23]
    ds_read_b64_tr_b16 a[164:165], v9 offset:8192
    ds_read_b64_tr_b16 a[166:167], v9 offset:12288
    v_mfma_f32_16x16x32_bf16 a[24:27], a[168:171], v[112:115], a[24:27]
    v_exp_f32 v60, v60
    v_mfma_f32_16x16x32_bf16 a[24:27], a[172:175], v[116:119], a[24:27]
    v_exp_f32 v61, v61
    v_mfma_f32_16x16x32_bf16 a[28:31], a[168:171], v[120:123], a[28:31]
    v_cvt_pk_bf16_f32 v139, v54, v55
    v_cvt_pk_bf16_f32 v146, v56, v57
    v_mfma_f32_16x16x32_bf16 a[28:31], a[172:175], v[124:127], a[28:31]
    v_exp_f32 v62, v62
    v_smfmac_f32_16x16x64_bf16 a[188:191], a[200:203], v[104:111], v18
    s_waitcnt lgkmcnt(4)
    v_cvt_pk_bf16_f32 v147, v58, v59
    v_cvt_pk_bf16_f32 v154, v60, v61
    v_mfma_f32_16x16x32_bf16 a[32:35], a[176:179], v[96:99], a[32:35]
    v_exp_f32 v63, v63
    v_mfma_f32_16x16x32_bf16 a[32:35], a[180:183], v[100:103], a[32:35]
    ds_read_b64_tr_b16 a[168:169], v10 offset:0
    ds_read_b64_tr_b16 a[170:171], v10 offset:4096
    v_mfma_f32_16x16x32_bf16 a[36:39], a[176:179], v[104:107], a[36:39]
    v_exp_f32 v64, v64
    v_mfma_f32_16x16x32_bf16 a[36:39], a[180:183], v[108:111], a[36:39]
    v_exp_f32 v65, v65
    v_mfma_f32_16x16x32_bf16 a[40:43], a[176:179], v[112:115], a[40:43]
    ds_read_b64_tr_b16 a[172:173], v10 offset:8192
    ds_read_b64_tr_b16 a[174:175], v10 offset:12288
    v_mfma_f32_16x16x32_bf16 a[40:43], a[180:183], v[116:119], a[40:43]
    v_exp_f32 v66, v66
    v_mfma_f32_16x16x32_bf16 a[44:47], a[176:179], v[120:123], a[44:47]
    v_cvt_pk_bf16_f32 v155, v62, v63
    v_cvt_pk_bf16_f32 v132, v64, v65
    v_mfma_f32_16x16x32_bf16 a[44:47], a[180:183], v[124:127], a[44:47]
    v_exp_f32 v67, v67
    v_smfmac_f32_16x16x64_bf16 a[192:195], a[200:203], v[112:119], v18
    s_waitcnt lgkmcnt(4)
    v_exp_f32 v68, v68
    v_mfma_f32_16x16x32_bf16 a[48:51], a[160:163], v[96:99], a[48:51]
    ds_read_b64_tr_b16 a[176:177], v11 offset:0
    ds_read_b64_tr_b16 a[178:179], v11 offset:4096
    v_mfma_f32_16x16x32_bf16 a[48:51], a[164:167], v[100:103], a[48:51]
    v_exp_f32 v69, v69
    v_mfma_f32_16x16x32_bf16 a[52:55], a[160:163], v[104:107], a[52:55]
    ds_read_b64_tr_b16 a[180:181], v11 offset:8192
    ds_read_b64_tr_b16 a[182:183], v11 offset:12288
    v_mfma_f32_16x16x32_bf16 a[52:55], a[164:167], v[108:111], a[52:55]
    v_exp_f32 v70, v70
    v_mfma_f32_16x16x32_bf16 a[56:59], a[160:163], v[112:115], a[56:59]
    v_cvt_pk_bf16_f32 v133, v66, v67
    v_cvt_pk_bf16_f32 v140, v68, v69
    v_mfma_f32_16x16x32_bf16 a[56:59], a[164:167], v[116:119], a[56:59]
    v_exp_f32 v71, v71
    v_mfma_f32_16x16x32_bf16 a[60:63], a[160:163], v[120:123], a[60:63]
    v_exp_f32 v72, v72
    v_mfma_f32_16x16x32_bf16 a[60:63], a[164:167], v[124:127], a[60:63]
    v_cvt_pk_bf16_f32 v141, v70, v71
    v_smfmac_f32_16x16x64_bf16 a[196:199], a[200:203], v[120:127], v18
    s_waitcnt lgkmcnt(4)
    v_exp_f32 v73, v73
    v_mfma_f32_16x16x32_bf16 a[64:67], a[168:171], v[96:99], a[64:67]
    ds_read_b64_tr_b16 a[160:161], v12 offset:0
    ds_read_b64_tr_b16 a[162:163], v12 offset:4096
    v_mfma_f32_16x16x32_bf16 a[64:67], a[172:175], v[100:103], a[64:67]
    v_exp_f32 v74, v74
    v_mfma_f32_16x16x32_bf16 a[68:71], a[168:171], v[104:107], a[68:71]
    v_exp_f32 v75, v75
    v_mfma_f32_16x16x32_bf16 a[68:71], a[172:175], v[108:111], a[68:71]
    ds_read_b64_tr_b16 a[164:165], v12 offset:8192
    ds_read_b64_tr_b16 a[166:167], v12 offset:12288
    v_mfma_f32_16x16x32_bf16 a[72:75], a[168:171], v[112:115], a[72:75]
    v_exp_f32 v76, v76
    v_mfma_f32_16x16x32_bf16 a[72:75], a[172:175], v[116:119], a[72:75]
    ds_read_b128 a[128:131], v2 offset:0
    ds_read_b128 a[132:135], v3 offset:0
    v_mfma_f32_16x16x32_bf16 a[76:79], a[168:171], v[120:123], a[76:79]
    v_exp_f32 v77, v77
    v_mfma_f32_16x16x32_bf16 a[76:79], a[172:175], v[124:127], a[76:79]
    s_waitcnt lgkmcnt(6)
    ds_read_b128 a[136:139], v4 offset:0
    ds_read_b128 a[140:143], v5 offset:0
    v_mfma_f32_16x16x32_bf16 a[80:83], a[176:179], v[96:99], a[80:83]
    v_exp_f32 v78, v78
    v_mfma_f32_16x16x32_bf16 a[80:83], a[180:183], v[100:103], a[80:83]
    v_exp_f32 v79, v79
    v_mfma_f32_16x16x32_bf16 a[84:87], a[176:179], v[104:107], a[84:87]
    ds_read_b64_tr_b16 a[168:169], v13 offset:0
    ds_read_b64_tr_b16 a[170:171], v13 offset:4096
    v_mfma_f32_16x16x32_bf16 a[84:87], a[180:183], v[108:111], a[84:87]
    v_exp_f32 v80, v80
    v_mfma_f32_16x16x32_bf16 a[88:91], a[176:179], v[112:115], a[88:91]
    ds_read_b64_tr_b16 a[172:173], v13 offset:8192
    ds_read_b64_tr_b16 a[174:175], v13 offset:12288
    v_mfma_f32_16x16x32_bf16 a[88:91], a[180:183], v[116:119], a[88:91]
    v_exp_f32 v81, v81
    v_mfma_f32_16x16x32_bf16 a[92:95], a[176:179], v[120:123], a[92:95]
    v_exp_f32 v82, v82
    v_mfma_f32_16x16x32_bf16 a[92:95], a[180:183], v[124:127], a[92:95]
    s_waitcnt lgkmcnt(8)
    v_add_u32 v248, 1, v248
    v_cvt_pk_bf16_f32 v148, v72, v73
    v_mfma_f32_16x16x32_bf16 a[96:99], a[160:163], v[96:99], a[96:99]
    v_exp_f32 v83, v83
    v_mfma_f32_16x16x32_bf16 a[96:99], a[164:167], v[100:103], a[96:99]
    v_exp_f32 v84, v84
    v_mfma_f32_16x16x32_bf16 a[100:103], a[160:163], v[104:107], a[100:103]
    s_waitcnt vmcnt(2) lgkmcnt(0)
    ds_write_b32 v255, v248
    v_cvt_pk_bf16_f32 v149, v74, v75
    v_mfma_f32_16x16x32_bf16 a[100:103], a[164:167], v[108:111], a[100:103]
    v_cvt_pk_bf16_f32 v156, v76, v77
    v_cvt_pk_bf16_f32 v157, v78, v79
    v_mfma_f32_16x16x32_bf16 a[104:107], a[160:163], v[112:115], a[104:107]
    v_exp_f32 v85, v85
    v_mfma_f32_16x16x32_bf16 a[104:107], a[164:167], v[116:119], a[104:107]
    v_exp_f32 v86, v86
    v_mfma_f32_16x16x32_bf16 a[108:111], a[160:163], v[120:123], a[108:111]
    v_cvt_pk_bf16_f32 v134, v80, v81
    v_cvt_pk_bf16_f32 v135, v82, v83
    v_mfma_f32_16x16x32_bf16 a[108:111], a[164:167], v[124:127], a[108:111]
    v_exp_f32 v87, v87
    v_mfma_f32_16x16x32_bf16 a[112:115], a[168:171], v[96:99], a[112:115]
    v_cvt_pk_bf16_f32 v142, v84, v85
    v_cvt_pk_bf16_f32 v143, v86, v87
    v_mfma_f32_16x16x32_bf16 a[112:115], a[172:175], v[100:103], a[112:115]
    v_exp_f32 v88, v88
    v_mfma_f32_16x16x32_bf16 a[116:119], a[168:171], v[104:107], a[116:119]
    v_exp_f32 v89, v89
    v_mfma_f32_16x16x32_bf16 a[116:119], a[172:175], v[108:111], a[116:119]
    v_cvt_pk_bf16_f32 v150, v88, v89
    v_mfma_f32_16x16x32_bf16 a[120:123], a[168:171], v[112:115], a[120:123]
    v_exp_f32 v90, v90
    v_mfma_f32_16x16x32_bf16 a[120:123], a[172:175], v[116:119], a[120:123]
    v_mfma_f32_16x16x32_bf16 a[124:127], a[168:171], v[120:123], a[124:127]
    v_exp_f32 v91, v91
    v_mfma_f32_16x16x32_bf16 a[124:127], a[172:175], v[124:127], a[124:127]
    s_bitcmp1_b32 s94, s57
    v_exp_f32 v92, v92
    s_cbranch_scc1 L_evt0_standalone__tree_speculative_verify_tree_attention_over_candidate_token_tree__prompt_kernel
L_spec0r_standalone__tree_speculative_verify_tree_attention_over_candidate_token_tree__prompt_kernel:
    s_waitcnt lgkmcnt(0)
    v_mfma_f32_16x16x32_bf16 v[32:35], a[128:131], v[160:163], 0
    s_add_u32 s57, s57, 1
    v_exp_f32 v93, v93
    v_mfma_f32_16x16x32_bf16 v[32:35], a[132:135], v[164:167], v[32:35]
    ds_read_b128 a[144:147], v2 offset:4096
    ds_read_b128 a[148:151], v3 offset:4096
    v_mfma_f32_16x16x32_bf16 v[32:35], a[136:139], v[168:171], v[32:35]
    v_mfma_f32_16x16x32_bf16 v[32:35], a[140:143], v[172:175], v[32:35]
    v_exp_f32 v94, v94
    v_mfma_f32_16x16x32_bf16 v[36:39], a[128:131], v[176:179], 0
    v_cvt_pk_bf16_f32 v151, v90, v91
    v_cvt_pk_bf16_f32 v158, v92, v93
    v_mfma_f32_16x16x32_bf16 v[36:39], a[132:135], v[180:183], v[36:39]
    ds_read_b128 a[152:155], v4 offset:4096
    ds_read_b128 a[156:159], v5 offset:4096
    v_mfma_f32_16x16x32_bf16 v[36:39], a[136:139], v[184:187], v[36:39]
    v_mfma_f32_16x16x32_bf16 v[36:39], a[140:143], v[188:191], v[36:39]
    v_exp_f32 v95, v95
    v_mfma_f32_16x16x32_bf16 v[40:43], a[128:131], v[192:195], 0
    v_exp_f32 v32, v32
    v_mfma_f32_16x16x32_bf16 v[40:43], a[132:135], v[196:199], v[40:43]
    v_mfma_f32_16x16x32_bf16 v[40:43], a[136:139], v[200:203], v[40:43]
    v_mfma_f32_16x16x32_bf16 v[40:43], a[140:143], v[204:207], v[40:43]
    v_exp_f32 v33, v33
    v_mfma_f32_16x16x32_bf16 v[44:47], a[128:131], v[208:211], 0
    v_exp_f32 v34, v34
    v_mfma_f32_16x16x32_bf16 v[44:47], a[132:135], v[212:215], v[44:47]
    v_mfma_f32_16x16x32_bf16 v[44:47], a[136:139], v[216:219], v[44:47]
    v_mfma_f32_16x16x32_bf16 v[44:47], a[140:143], v[220:223], v[44:47]
    s_waitcnt lgkmcnt(0)
    v_cvt_pk_bf16_f32 v96, v32, v33
    v_cvt_pk_bf16_f32 v159, v94, v95
    v_mfma_f32_16x16x32_bf16 v[48:51], a[144:147], v[160:163], 0
    v_exp_f32 v35, v35
    v_mfma_f32_16x16x32_bf16 v[48:51], a[148:151], v[164:167], v[48:51]
    ds_read_b32 v252, v253
    ds_read_b128 a[128:131], v2 offset:8192
    v_mfma_f32_16x16x32_bf16 v[48:51], a[152:155], v[168:171], v[48:51]
    v_mfma_f32_16x16x32_bf16 v[48:51], a[156:159], v[172:175], v[48:51]
    v_exp_f32 v36, v36
    v_mfma_f32_16x16x32_bf16 v[52:55], a[144:147], v[176:179], 0
    v_exp_f32 v37, v37
    v_mfma_f32_16x16x32_bf16 v[52:55], a[148:151], v[180:183], v[52:55]
    ds_read_b128 a[132:135], v3 offset:8192
    ds_read_b128 a[136:139], v4 offset:8192
    v_mfma_f32_16x16x32_bf16 v[52:55], a[152:155], v[184:187], v[52:55]
    v_mfma_f32_16x16x32_bf16 v[52:55], a[156:159], v[188:191], v[52:55]
    v_cvt_pk_bf16_f32 v97, v34, v35
    v_cvt_pk_bf16_f32 v104, v36, v37
    v_mfma_f32_16x16x32_bf16 v[56:59], a[144:147], v[192:195], 0
    v_exp_f32 v38, v38
    v_mfma_f32_16x16x32_bf16 v[56:59], a[148:151], v[196:199], v[56:59]
    ds_read_b128 a[140:143], v5 offset:8192
    v_mfma_f32_16x16x32_bf16 v[56:59], a[152:155], v[200:203], v[56:59]
    v_mfma_f32_16x16x32_bf16 v[56:59], a[156:159], v[204:207], v[56:59]
    v_exp_f32 v39, v39
    v_mfma_f32_16x16x32_bf16 v[60:63], a[144:147], v[208:211], 0
    v_exp_f32 v40, v40
    v_mfma_f32_16x16x32_bf16 v[60:63], a[148:151], v[212:215], v[60:63]
    s_waitcnt lgkmcnt(4)
    v_cmp_gt_u32 vcc, v248, v252
    v_mfma_f32_16x16x32_bf16 v[60:63], a[152:155], v[216:219], v[60:63]
    s_cbranch_vccnz L_spinb_standalone__tree_speculative_verify_tree_attention_over_candidate_token_tree__prompt_kernel
L_spinrb_standalone__tree_speculative_verify_tree_attention_over_candidate_token_tree__prompt_kernel:
    v_mfma_f32_16x16x32_bf16 v[60:63], a[156:159], v[220:223], v[60:63]
    s_waitcnt lgkmcnt(0)
    v_exp_f32 v41, v41
    v_mfma_f32_16x16x32_bf16 v[64:67], a[128:131], v[160:163], 0
    v_cvt_pk_bf16_f32 v105, v38, v39
    v_cvt_pk_bf16_f32 v112, v40, v41
    v_mfma_f32_16x16x32_bf16 v[64:67], a[132:135], v[164:167], v[64:67]
    s_add_u32 m0, s58, s92
    ds_read_b128 a[144:147], v2 offset:12288
    ds_read_b128 a[148:151], v3 offset:12288
    v_mfma_f32_16x16x32_bf16 v[64:67], a[136:139], v[168:171], v[64:67]
    buffer_load_dwordx4 v14, s[24:27], s55 offen offset:0  lds
    v_mfma_f32_16x16x32_bf16 v[64:67], a[140:143], v[172:175], v[64:67]
    v_exp_f32 v42, v42
    v_mfma_f32_16x16x32_bf16 v[68:71], a[128:131], v[176:179], 0
    v_exp_f32 v43, v43
    v_mfma_f32_16x16x32_bf16 v[68:71], a[132:135], v[180:183], v[68:71]
    ds_read_b128 a[152:155], v4 offset:12288
    ds_read_b128 a[156:159], v5 offset:12288
    v_mfma_f32_16x16x32_bf16 v[68:71], a[136:139], v[184:187], v[68:71]
    s_sub_u32 s93, s91, s90
    buffer_load_dwordx4 v15, s[24:27], s55 offen offset:1024  lds
    v_mfma_f32_16x16x32_bf16 v[68:71], a[140:143], v[188:191], v[68:71]
    v_exp_f32 v44, v44
    v_mfma_f32_16x16x32_bf16 v[72:75], a[128:131], v[192:195], 0
    s_mov_b32 s60, s90
    s_mov_b32 s90, s91
    s_mov_b32 s91, s92
    s_mov_b32 s92, s60
    v_exp_f32 v45, v45
    v_mfma_f32_16x16x32_bf16 v[72:75], a[132:135], v[196:199], v[72:75]
    v_add_u32 v2, s93, v2
    v_add_u32 v3, s93, v3
    v_mfma_f32_16x16x32_bf16 v[72:75], a[136:139], v[200:203], v[72:75]
    buffer_load_dwordx4 v14, s[24:27], s55 offen offset:2048  lds
    v_mfma_f32_16x16x32_bf16 v[72:75], a[140:143], v[204:207], v[72:75]
    v_add_u32 v4, s93, v4
    v_add_u32 v5, s93, v5
    v_mfma_f32_16x16x32_bf16 v[76:79], a[128:131], v[208:211], 0
    v_exp_f32 v46, v46
    v_mfma_f32_16x16x32_bf16 v[76:79], a[132:135], v[212:215], v[76:79]
    v_mfma_f32_16x16x32_bf16 v[76:79], a[136:139], v[216:219], v[76:79]
    buffer_load_dwordx4 v15, s[24:27], s55 offen offset:3072  lds
    v_mfma_f32_16x16x32_bf16 v[76:79], a[140:143], v[220:223], v[76:79]
    s_waitcnt lgkmcnt(0)
    v_exp_f32 v47, v47
    v_mfma_f32_16x16x32_bf16 v[80:83], a[144:147], v[160:163], 0
    v_exp_f32 v48, v48
    v_mfma_f32_16x16x32_bf16 v[80:83], a[148:151], v[164:167], v[80:83]
    s_add_u32 m0, s58, 49152
    ds_read_b64_tr_b16 a[160:161], v6 offset:16384
    ds_read_b64_tr_b16 a[162:163], v6 offset:20480
    v_mfma_f32_16x16x32_bf16 v[80:83], a[152:155], v[168:171], v[80:83]
    buffer_load_dwordx4 v14, s[28:31], s56 offen offset:0  lds
    v_mfma_f32_16x16x32_bf16 v[80:83], a[156:159], v[172:175], v[80:83]
    v_cvt_pk_bf16_f32 v113, v42, v43
    v_cvt_pk_bf16_f32 v120, v44, v45
    v_mfma_f32_16x16x32_bf16 v[84:87], a[144:147], v[176:179], 0
    v_exp_f32 v49, v49
    v_mfma_f32_16x16x32_bf16 v[84:87], a[148:151], v[180:183], v[84:87]
    ds_read_b64_tr_b16 a[164:165], v6 offset:24576
    ds_read_b64_tr_b16 a[166:167], v6 offset:28672
    v_mfma_f32_16x16x32_bf16 v[84:87], a[152:155], v[184:187], v[84:87]
    buffer_load_dwordx4 v15, s[28:31], s56 offen offset:1024  lds
    v_mfma_f32_16x16x32_bf16 v[84:87], a[156:159], v[188:191], v[84:87]
    v_exp_f32 v50, v50
    v_mfma_f32_16x16x32_bf16 v[88:91], a[144:147], v[192:195], 0
    v_exp_f32 v51, v51
    v_mfma_f32_16x16x32_bf16 v[88:91], a[148:151], v[196:199], v[88:91]
    ds_read_b64_tr_b16 a[168:169], v7 offset:16384
    ds_read_b64_tr_b16 a[170:171], v7 offset:20480
    v_mfma_f32_16x16x32_bf16 v[88:91], a[152:155], v[200:203], v[88:91]
    buffer_load_dwordx4 v14, s[28:31], s56 offen offset:2048  lds
    v_mfma_f32_16x16x32_bf16 v[88:91], a[156:159], v[204:207], v[88:91]
    v_exp_f32 v52, v52
    v_mfma_f32_16x16x32_bf16 v[92:95], a[144:147], v[208:211], 0
    v_cvt_pk_bf16_f32 v121, v46, v47
    v_cvt_pk_bf16_f32 v98, v48, v49
    v_mfma_f32_16x16x32_bf16 v[92:95], a[148:151], v[212:215], v[92:95]
    ds_read_b64_tr_b16 a[172:173], v7 offset:24576
    ds_read_b64_tr_b16 a[174:175], v7 offset:28672
    v_mfma_f32_16x16x32_bf16 v[92:95], a[152:155], v[216:219], v[92:95]
    buffer_load_dwordx4 v15, s[28:31], s56 offen offset:3072  lds
    v_mfma_f32_16x16x32_bf16 v[92:95], a[156:159], v[220:223], v[92:95]
    s_add_u32 s55, s55, 16384
    s_min_u32 s55, s55, 507904
    s_waitcnt lgkmcnt(4)
    v_exp_f32 v53, v53
    v_mfma_f32_16x16x32_bf16 a[0:3], a[160:163], v[128:131], a[0:3]
    s_add_u32 s56, s56, 16384
    v_exp_f32 v54, v54
    v_mfma_f32_16x16x32_bf16 a[0:3], a[164:167], v[132:135], a[0:3]
    s_mov_b32 m0, 160768
    ds_read_b64_tr_b16 a[176:177], v8 offset:16384
    ds_read_b64_tr_b16 a[178:179], v8 offset:20480
    v_mfma_f32_16x16x32_bf16 a[4:7], a[160:163], v[136:139], a[4:7]
    buffer_load_dwordx4 v249, s[28:31], s68 offen  lds
    v_mfma_f32_16x16x32_bf16 a[4:7], a[164:167], v[140:143], a[4:7]
    s_add_u32 s68, s68, 32768
    v_exp_f32 v55, v55
    v_mfma_f32_16x16x32_bf16 a[8:11], a[160:163], v[144:147], a[8:11]
    buffer_load_dwordx4 v246, s[44:47], s69 offen  lds
    v_mfma_f32_16x16x32_bf16 a[8:11], a[164:167], v[148:151], a[8:11]
    s_add_u32 s69, s69, 65536
    ds_read_b64_tr_b16 a[180:181], v8 offset:24576
    ds_read_b64_tr_b16 a[182:183], v8 offset:28672
    v_mfma_f32_16x16x32_bf16 a[12:15], a[160:163], v[152:155], a[12:15]
    v_exp_f32 v56, v56
    v_mfma_f32_16x16x32_bf16 a[12:15], a[164:167], v[156:159], a[12:15]
    v_cvt_pk_bf16_f32 v99, v50, v51
    v_cvt_pk_bf16_f32 v106, v52, v53
    v_smfmac_f32_16x16x64_bf16 a[184:187], a[200:203], v[128:135], v18
    s_waitcnt lgkmcnt(4)
    v_exp_f32 v57, v57
    v_mfma_f32_16x16x32_bf16 a[16:19], a[168:171], v[128:131], a[16:19]
    v_exp_f32 v58, v58
    v_mfma_f32_16x16x32_bf16 a[16:19], a[172:175], v[132:135], a[16:19]
    ds_read_b64_tr_b16 a[160:161], v9 offset:16384
    ds_read_b64_tr_b16 a[162:163], v9 offset:20480
    v_mfma_f32_16x16x32_bf16 a[20:23], a[168:171], v[136:139], a[20:23]
    v_exp_f32 v59, v59
    v_mfma_f32_16x16x32_bf16 a[20:23], a[172:175], v[140:143], a[20:23]
    ds_read_b64_tr_b16 a[164:165], v9 offset:24576
    ds_read_b64_tr_b16 a[166:167], v9 offset:28672
    v_mfma_f32_16x16x32_bf16 a[24:27], a[168:171], v[144:147], a[24:27]
    v_exp_f32 v60, v60
    v_mfma_f32_16x16x32_bf16 a[24:27], a[172:175], v[148:151], a[24:27]
    v_exp_f32 v61, v61
    v_mfma_f32_16x16x32_bf16 a[28:31], a[168:171], v[152:155], a[28:31]
    v_cvt_pk_bf16_f32 v107, v54, v55
    v_cvt_pk_bf16_f32 v114, v56, v57
    v_mfma_f32_16x16x32_bf16 a[28:31], a[172:175], v[156:159], a[28:31]
    v_exp_f32 v62, v62
    v_smfmac_f32_16x16x64_bf16 a[188:191], a[200:203], v[136:143], v18
    s_waitcnt lgkmcnt(4)
    v_cvt_pk_bf16_f32 v115, v58, v59
    v_cvt_pk_bf16_f32 v122, v60, v61
    v_mfma_f32_16x16x32_bf16 a[32:35], a[176:179], v[128:131], a[32:35]
    v_exp_f32 v63, v63
    v_mfma_f32_16x16x32_bf16 a[32:35], a[180:183], v[132:135], a[32:35]
    ds_read_b64_tr_b16 a[168:169], v10 offset:16384
    ds_read_b64_tr_b16 a[170:171], v10 offset:20480
    v_mfma_f32_16x16x32_bf16 a[36:39], a[176:179], v[136:139], a[36:39]
    v_exp_f32 v64, v64
    v_mfma_f32_16x16x32_bf16 a[36:39], a[180:183], v[140:143], a[36:39]
    v_exp_f32 v65, v65
    v_mfma_f32_16x16x32_bf16 a[40:43], a[176:179], v[144:147], a[40:43]
    ds_read_b64_tr_b16 a[172:173], v10 offset:24576
    ds_read_b64_tr_b16 a[174:175], v10 offset:28672
    v_mfma_f32_16x16x32_bf16 a[40:43], a[180:183], v[148:151], a[40:43]
    v_exp_f32 v66, v66
    v_mfma_f32_16x16x32_bf16 a[44:47], a[176:179], v[152:155], a[44:47]
    v_cvt_pk_bf16_f32 v123, v62, v63
    v_cvt_pk_bf16_f32 v100, v64, v65
    v_mfma_f32_16x16x32_bf16 a[44:47], a[180:183], v[156:159], a[44:47]
    v_exp_f32 v67, v67
    v_smfmac_f32_16x16x64_bf16 a[192:195], a[200:203], v[144:151], v18
    s_waitcnt lgkmcnt(4)
    v_exp_f32 v68, v68
    v_mfma_f32_16x16x32_bf16 a[48:51], a[160:163], v[128:131], a[48:51]
    ds_read_b64_tr_b16 a[176:177], v11 offset:16384
    ds_read_b64_tr_b16 a[178:179], v11 offset:20480
    v_mfma_f32_16x16x32_bf16 a[48:51], a[164:167], v[132:135], a[48:51]
    v_exp_f32 v69, v69
    v_mfma_f32_16x16x32_bf16 a[52:55], a[160:163], v[136:139], a[52:55]
    ds_read_b64_tr_b16 a[180:181], v11 offset:24576
    ds_read_b64_tr_b16 a[182:183], v11 offset:28672
    v_mfma_f32_16x16x32_bf16 a[52:55], a[164:167], v[140:143], a[52:55]
    v_exp_f32 v70, v70
    v_mfma_f32_16x16x32_bf16 a[56:59], a[160:163], v[144:147], a[56:59]
    v_cvt_pk_bf16_f32 v101, v66, v67
    v_cvt_pk_bf16_f32 v108, v68, v69
    v_mfma_f32_16x16x32_bf16 a[56:59], a[164:167], v[148:151], a[56:59]
    v_exp_f32 v71, v71
    v_mfma_f32_16x16x32_bf16 a[60:63], a[160:163], v[152:155], a[60:63]
    v_exp_f32 v72, v72
    v_mfma_f32_16x16x32_bf16 a[60:63], a[164:167], v[156:159], a[60:63]
    v_cvt_pk_bf16_f32 v109, v70, v71
    v_smfmac_f32_16x16x64_bf16 a[196:199], a[200:203], v[152:159], v18
    s_waitcnt lgkmcnt(4)
    v_exp_f32 v73, v73
    v_mfma_f32_16x16x32_bf16 a[64:67], a[168:171], v[128:131], a[64:67]
    ds_read_b64_tr_b16 a[160:161], v12 offset:16384
    ds_read_b64_tr_b16 a[162:163], v12 offset:20480
    v_mfma_f32_16x16x32_bf16 a[64:67], a[172:175], v[132:135], a[64:67]
    v_exp_f32 v74, v74
    v_mfma_f32_16x16x32_bf16 a[68:71], a[168:171], v[136:139], a[68:71]
    v_exp_f32 v75, v75
    v_mfma_f32_16x16x32_bf16 a[68:71], a[172:175], v[140:143], a[68:71]
    ds_read_b64_tr_b16 a[164:165], v12 offset:24576
    ds_read_b64_tr_b16 a[166:167], v12 offset:28672
    v_mfma_f32_16x16x32_bf16 a[72:75], a[168:171], v[144:147], a[72:75]
    v_exp_f32 v76, v76
    v_mfma_f32_16x16x32_bf16 a[72:75], a[172:175], v[148:151], a[72:75]
    ds_read_b128 a[128:131], v2 offset:0
    ds_read_b128 a[132:135], v3 offset:0
    v_mfma_f32_16x16x32_bf16 a[76:79], a[168:171], v[152:155], a[76:79]
    v_exp_f32 v77, v77
    v_mfma_f32_16x16x32_bf16 a[76:79], a[172:175], v[156:159], a[76:79]
    s_waitcnt lgkmcnt(6)
    ds_read_b128 a[136:139], v4 offset:0
    ds_read_b128 a[140:143], v5 offset:0
    v_mfma_f32_16x16x32_bf16 a[80:83], a[176:179], v[128:131], a[80:83]
    v_exp_f32 v78, v78
    v_mfma_f32_16x16x32_bf16 a[80:83], a[180:183], v[132:135], a[80:83]
    v_exp_f32 v79, v79
    v_mfma_f32_16x16x32_bf16 a[84:87], a[176:179], v[136:139], a[84:87]
    ds_read_b64_tr_b16 a[168:169], v13 offset:16384
    ds_read_b64_tr_b16 a[170:171], v13 offset:20480
    v_mfma_f32_16x16x32_bf16 a[84:87], a[180:183], v[140:143], a[84:87]
    v_exp_f32 v80, v80
    v_mfma_f32_16x16x32_bf16 a[88:91], a[176:179], v[144:147], a[88:91]
    ds_read_b64_tr_b16 a[172:173], v13 offset:24576
    ds_read_b64_tr_b16 a[174:175], v13 offset:28672
    v_mfma_f32_16x16x32_bf16 a[88:91], a[180:183], v[148:151], a[88:91]
    v_exp_f32 v81, v81
    v_mfma_f32_16x16x32_bf16 a[92:95], a[176:179], v[152:155], a[92:95]
    v_exp_f32 v82, v82
    v_mfma_f32_16x16x32_bf16 a[92:95], a[180:183], v[156:159], a[92:95]
    s_waitcnt lgkmcnt(8)
    v_add_u32 v248, 1, v248
    v_cvt_pk_bf16_f32 v116, v72, v73
    v_mfma_f32_16x16x32_bf16 a[96:99], a[160:163], v[128:131], a[96:99]
    v_exp_f32 v83, v83
    v_mfma_f32_16x16x32_bf16 a[96:99], a[164:167], v[132:135], a[96:99]
    s_cmp_eq_u32 s57, 1
    s_cbranch_scc1 L_w0b_standalone__tree_speculative_verify_tree_attention_over_candidate_token_tree__prompt_kernel
L_w0rb_standalone__tree_speculative_verify_tree_attention_over_candidate_token_tree__prompt_kernel:
    v_exp_f32 v84, v84
    v_mfma_f32_16x16x32_bf16 a[100:103], a[160:163], v[136:139], a[100:103]
    s_waitcnt vmcnt(2) lgkmcnt(0)
    ds_write_b32 v255, v248
    v_cvt_pk_bf16_f32 v117, v74, v75
    v_mfma_f32_16x16x32_bf16 a[100:103], a[164:167], v[140:143], a[100:103]
    v_cvt_pk_bf16_f32 v124, v76, v77
    v_cvt_pk_bf16_f32 v125, v78, v79
    v_mfma_f32_16x16x32_bf16 a[104:107], a[160:163], v[144:147], a[104:107]
    v_exp_f32 v85, v85
    v_mfma_f32_16x16x32_bf16 a[104:107], a[164:167], v[148:151], a[104:107]
    v_exp_f32 v86, v86
    v_mfma_f32_16x16x32_bf16 a[108:111], a[160:163], v[152:155], a[108:111]
    v_cvt_pk_bf16_f32 v102, v80, v81
    v_cvt_pk_bf16_f32 v103, v82, v83
    v_mfma_f32_16x16x32_bf16 a[108:111], a[164:167], v[156:159], a[108:111]
    v_exp_f32 v87, v87
    v_mfma_f32_16x16x32_bf16 a[112:115], a[168:171], v[128:131], a[112:115]
    v_cvt_pk_bf16_f32 v110, v84, v85
    v_cvt_pk_bf16_f32 v111, v86, v87
    v_mfma_f32_16x16x32_bf16 a[112:115], a[172:175], v[132:135], a[112:115]
    v_exp_f32 v88, v88
    v_mfma_f32_16x16x32_bf16 a[116:119], a[168:171], v[136:139], a[116:119]
    v_exp_f32 v89, v89
    v_mfma_f32_16x16x32_bf16 a[116:119], a[172:175], v[140:143], a[116:119]
    v_cvt_pk_bf16_f32 v118, v88, v89
    v_mfma_f32_16x16x32_bf16 a[120:123], a[168:171], v[144:147], a[120:123]
    v_exp_f32 v90, v90
    v_mfma_f32_16x16x32_bf16 a[120:123], a[172:175], v[148:151], a[120:123]
    v_mfma_f32_16x16x32_bf16 a[124:127], a[168:171], v[152:155], a[124:127]
    v_exp_f32 v91, v91
    v_mfma_f32_16x16x32_bf16 a[124:127], a[172:175], v[156:159], a[124:127]
    s_bitcmp1_b32 s94, s57
    v_exp_f32 v92, v92
    s_cbranch_scc0 L_loop_standalone__tree_speculative_verify_tree_attention_over_candidate_token_tree__prompt_kernel
    s_cmp_eq_u32 s57, 5
    s_cbranch_scc1 L_stA_standalone__tree_speculative_verify_tree_attention_over_candidate_token_tree__prompt_kernel
    s_cmp_eq_u32 s57, 7
    s_cbranch_scc0 L_start_standalone__tree_speculative_verify_tree_attention_over_candidate_token_tree__prompt_kernel
    s_cmp_lg_u32 s96, 0
    s_cbranch_scc1 L_loop_standalone__tree_speculative_verify_tree_attention_over_candidate_token_tree__prompt_kernel
    v_readfirstlane_b32 s84, v224
    v_readfirstlane_b32 s85, v225
    v_readfirstlane_b32 s86, v226
    v_readfirstlane_b32 s87, v227
    s_nop 0
    s_add_u32 s63, s84, s85
    s_max_u32 s89, s84, s85
    s_mov_b32 s64, 0x11111111
    s_mov_b32 s65, 0
    s_mov_b32 s76, 0
    s_min_u32 s60, s84, 8
    s_lshl_b32 s60, s60, 2
    s_sub_u32 s60, 32, s60
    s_lshr_b64 s[66:67], s[64:65], s60
    s_lshl_b32 s66, s66, 0
    s_or_b32 s76, s76, s66
    s_min_u32 s60, s85, 8
    s_lshl_b32 s60, s60, 2
    s_sub_u32 s60, 32, s60
    s_lshr_b64 s[66:67], s[64:65], s60
    s_lshl_b32 s66, s66, 1
    s_or_b32 s76, s76, s66
    s_add_u32 s63, s63, s86
    s_max_u32 s89, s89, s86
    s_min_u32 s60, s86, 8
    s_lshl_b32 s60, s60, 2
    s_sub_u32 s60, 32, s60
    s_lshr_b64 s[66:67], s[64:65], s60
    s_lshl_b32 s66, s66, 2
    s_or_b32 s76, s76, s66
    s_add_u32 s63, s63, s87
    s_max_u32 s89, s89, s87
    s_min_u32 s60, s87, 8
    s_lshl_b32 s60, s60, 2
    s_sub_u32 s60, 32, s60
    s_lshr_b64 s[66:67], s[64:65], s60
    s_lshl_b32 s66, s66, 3
    s_or_b32 s76, s76, s66
    s_cmp_gt_u32 s89, 7
    s_cselect_b32 s96, 1, 0
    s_cmp_gt_u32 s63, 28
    s_cselect_b32 s96, 1, s96
    s_cmp_lg_u32 s96, 0
    s_cselect_b32 s76, 0, s76
    s_lshl_b32 s63, s63, 1
    s_sub_i32 s63, 29, s63
    s_cmp_le_i32 s63, 7
    s_cbranch_scc1 L_start_standalone__tree_speculative_verify_tree_attention_over_candidate_token_tree__prompt_kernel
    s_bitset1_b32 s94, s63
    s_branch L_loop_standalone__tree_speculative_verify_tree_attention_over_candidate_token_tree__prompt_kernel
L_start_standalone__tree_speculative_verify_tree_attention_over_candidate_token_tree__prompt_kernel:
    s_ff1_i32_b32 s83, s76
    s_min_u32 s83, s83, 32
    s_add_u32 s62, s76, -1
    s_and_b32 s76, s76, s62
    s_cmp_eq_u32 s83, 0
    s_cbranch_scc1 L_adv0_standalone__tree_speculative_verify_tree_attention_over_candidate_token_tree__prompt_kernel
    s_and_b32 s60, s83, 3
    s_lshl_b32 s60, s60, 17
    s_lshr_b32 s61, s83, 2
    s_and_b32 s61, s61, 7
    s_lshl_b32 s61, s61, 11
    s_add_u32 s81, s60, s61
    s_add_u32 s81, s81, s77
    buffer_load_dwordx4 v[228:231], v19, s[48:51], s81 offen offset:128 sc1
    buffer_load_dwordx4 v[232:235], v19, s[48:51], s81 offen offset:144 sc1
    s_waitcnt vmcnt(0)
L_adv0_standalone__tree_speculative_verify_tree_attention_over_candidate_token_tree__prompt_kernel:
    s_mov_b32 s82, s83
    s_mov_b32 s80, s81
    s_ff1_i32_b32 s83, s76
    s_min_u32 s83, s83, 32
    s_add_u32 s62, s76, -1
    s_and_b32 s76, s76, s62
    s_and_b32 s60, s83, 3
    s_lshl_b32 s60, s60, 17
    s_lshr_b32 s61, s83, 2
    s_and_b32 s61, s61, 7
    s_lshl_b32 s61, s61, 11
    s_add_u32 s81, s60, s61
    s_add_u32 s81, s81, s77
    s_and_b32 s97, s82, 3
    s_add_u32 s62, s57, 2
    s_cmp_lt_u32 s82, 32
    s_cselect_b32 s79, 0, 0x80000000
    s_cselect_b32 s97, s97, 4
    s_cselect_b32 s62, s62, 31
    s_bitset1_b32 s94, s62
    v_or3_b32 v236, v228, v16, s79
    v_or3_b32 v237, v229, v17, s79
    v_or3_b32 v238, v230, v16, s79
    v_or3_b32 v239, v231, v17, s79
    v_or3_b32 v240, v232, v16, s79
    v_or3_b32 v241, v233, v17, s79
    v_or3_b32 v242, v234, v16, s79
    v_or3_b32 v243, v235, v17, s79
    buffer_load_dwordx4 v[224:227], v20, s[48:51], s80 offen sc1
    buffer_load_dwordx4 v[228:231], v19, s[48:51], s81 offen offset:128 sc1
    buffer_load_dwordx4 v[232:235], v19, s[48:51], s81 offen offset:144 sc1
    s_cmp_lt_u32 s97, 4
    s_cbranch_scc1 L_loopB_standalone__tree_speculative_verify_tree_attention_over_candidate_token_tree__prompt_kernel
    s_branch L_loop_standalone__tree_speculative_verify_tree_attention_over_candidate_token_tree__prompt_kernel
L_stA_standalone__tree_speculative_verify_tree_attention_over_candidate_token_tree__prompt_kernel:
    s_cmp_lg_u32 s54, 3
    s_cbranch_scc1 L_loop_standalone__tree_speculative_verify_tree_attention_over_candidate_token_tree__prompt_kernel
    s_mov_b32 s64, s18
    s_and_b32 s65, s19, 0xffff
    s_mov_b32 s66, 0x100
    s_mov_b32 s67, 0x20000
    s_and_b32 s60, s53, 3
    s_lshl_b32 s60, s60, 6
    s_lshr_b32 s61, s53, 2
    s_lshl_b32 s61, s61, 2
    s_add_u32 s60, s60, s61
    buffer_load_dword v247, off, s[64:67], s60 sc1
    s_branch L_loop_standalone__tree_speculative_verify_tree_attention_over_candidate_token_tree__prompt_kernel
.p2align 6
L_loopB_standalone__tree_speculative_verify_tree_attention_over_candidate_token_tree__prompt_kernel:
    s_waitcnt lgkmcnt(0)
    v_mfma_f32_16x16x32_bf16 v[32:35], a[128:131], v[160:163], 0
    s_add_u32 s57, s57, 1
    v_exp_f32 v93, v93
    v_mfma_f32_16x16x32_bf16 v[32:35], a[132:135], v[164:167], v[32:35]
    s_add_u32 m0, s78, 0
    ds_read_b128 a[144:147], v2 offset:4096
    ds_read_b128 a[148:151], v3 offset:4096
    v_mfma_f32_16x16x32_bf16 v[32:35], a[136:139], v[168:171], v[32:35]
    buffer_load_dwordx4 v236, s[40:43], 0 offen  lds
    v_mfma_f32_16x16x32_bf16 v[32:35], a[140:143], v[172:175], v[32:35]
    v_exp_f32 v94, v94
    v_mfma_f32_16x16x32_bf16 v[36:39], a[128:131], v[176:179], 0
    v_cvt_pk_bf16_f32 v119, v90, v91
    v_cvt_pk_bf16_f32 v126, v92, v93
    v_mfma_f32_16x16x32_bf16 v[36:39], a[132:135], v[180:183], v[36:39]
    s_add_u32 m0, s78, 1024
    ds_read_b128 a[152:155], v4 offset:4096
    ds_read_b128 a[156:159], v5 offset:4096
    v_mfma_f32_16x16x32_bf16 v[36:39], a[136:139], v[184:187], v[36:39]
    buffer_load_dwordx4 v237, s[40:43], 0 offen  lds
    v_mfma_f32_16x16x32_bf16 v[36:39], a[140:143], v[188:191], v[36:39]
    v_exp_f32 v95, v95
    v_mfma_f32_16x16x32_bf16 v[40:43], a[128:131], v[192:195], 0
    v_exp_f32 v32, v32
    v_mfma_f32_16x16x32_bf16 v[40:43], a[132:135], v[196:199], v[40:43]
    s_add_u32 m0, s78, 2048
    v_mfma_f32_16x16x32_bf16 v[40:43], a[136:139], v[200:203], v[40:43]
    buffer_load_dwordx4 v238, s[40:43], 0 offen  lds
    v_mfma_f32_16x16x32_bf16 v[40:43], a[140:143], v[204:207], v[40:43]
    v_exp_f32 v33, v33
    v_mfma_f32_16x16x32_bf16 v[44:47], a[128:131], v[208:211], 0
    v_exp_f32 v34, v34
    v_mfma_f32_16x16x32_bf16 v[44:47], a[132:135], v[212:215], v[44:47]
    s_add_u32 m0, s78, 3072
    v_mfma_f32_16x16x32_bf16 v[44:47], a[136:139], v[216:219], v[44:47]
    buffer_load_dwordx4 v239, s[40:43], 0 offen  lds
    v_mfma_f32_16x16x32_bf16 v[44:47], a[140:143], v[220:223], v[44:47]
    s_waitcnt lgkmcnt(0)
    v_cvt_pk_bf16_f32 v128, v32, v33
    v_cvt_pk_bf16_f32 v127, v94, v95
    v_mfma_f32_16x16x32_bf16 v[48:51], a[144:147], v[160:163], 0
    v_exp_f32 v35, v35
    v_mfma_f32_16x16x32_bf16 v[48:51], a[148:151], v[164:167], v[48:51]
    s_add_u32 m0, s78, 4096
    ds_read_b32 v252, v253
    ds_read_b128 a[128:131], v2 offset:8192
    v_mfma_f32_16x16x32_bf16 v[48:51], a[152:155], v[168:171], v[48:51]
    buffer_load_dwordx4 v240, s[40:43], 0 offen  lds
    v_mfma_f32_16x16x32_bf16 v[48:51], a[156:159], v[172:175], v[48:51]
    v_exp_f32 v36, v36
    v_mfma_f32_16x16x32_bf16 v[52:55], a[144:147], v[176:179], 0
    v_exp_f32 v37, v37
    v_mfma_f32_16x16x32_bf16 v[52:55], a[148:151], v[180:183], v[52:55]
    s_add_u32 m0, s78, 5120
    ds_read_b128 a[132:135], v3 offset:8192
    ds_read_b128 a[136:139], v4 offset:8192
    v_mfma_f32_16x16x32_bf16 v[52:55], a[152:155], v[184:187], v[52:55]
    buffer_load_dwordx4 v241, s[40:43], 0 offen  lds
    v_mfma_f32_16x16x32_bf16 v[52:55], a[156:159], v[188:191], v[52:55]
    v_cvt_pk_bf16_f32 v129, v34, v35
    v_cvt_pk_bf16_f32 v136, v36, v37
    v_mfma_f32_16x16x32_bf16 v[56:59], a[144:147], v[192:195], 0
    v_exp_f32 v38, v38
    v_mfma_f32_16x16x32_bf16 v[56:59], a[148:151], v[196:199], v[56:59]
    s_add_u32 m0, s78, 6144
    ds_read_b128 a[140:143], v5 offset:8192
    v_mfma_f32_16x16x32_bf16 v[56:59], a[152:155], v[200:203], v[56:59]
    buffer_load_dwordx4 v242, s[40:43], 0 offen  lds
    v_mfma_f32_16x16x32_bf16 v[56:59], a[156:159], v[204:207], v[56:59]
    v_exp_f32 v39, v39
    v_mfma_f32_16x16x32_bf16 v[60:63], a[144:147], v[208:211], 0
    v_exp_f32 v40, v40
    v_mfma_f32_16x16x32_bf16 v[60:63], a[148:151], v[212:215], v[60:63]
    s_add_u32 m0, s78, 7168
    s_waitcnt lgkmcnt(4)
    v_cmp_gt_u32 vcc, v248, v252
    v_mfma_f32_16x16x32_bf16 v[60:63], a[152:155], v[216:219], v[60:63]
    s_cbranch_vccnz L_spinc_standalone__tree_speculative_verify_tree_attention_over_candidate_token_tree__prompt_kernel
L_spinrc_standalone__tree_speculative_verify_tree_attention_over_candidate_token_tree__prompt_kernel:
    buffer_load_dwordx4 v243, s[40:43], 0 offen  lds
    v_mfma_f32_16x16x32_bf16 v[60:63], a[156:159], v[220:223], v[60:63]
    s_waitcnt lgkmcnt(0)
    v_exp_f32 v41, v41
    v_mfma_f32_16x16x32_bf16 v[64:67], a[128:131], v[160:163], 0
    v_cvt_pk_bf16_f32 v137, v38, v39
    v_cvt_pk_bf16_f32 v144, v40, v41
    v_mfma_f32_16x16x32_bf16 v[64:67], a[132:135], v[164:167], v[64:67]
    s_add_u32 m0, s58, s92
    ds_read_b128 a[144:147], v2 offset:12288
    ds_read_b128 a[148:151], v3 offset:12288
    v_mfma_f32_16x16x32_bf16 v[64:67], a[136:139], v[168:171], v[64:67]
    buffer_load_dwordx4 v14, s[24:27], s55 offen offset:0  lds
    v_mfma_f32_16x16x32_bf16 v[64:67], a[140:143], v[172:175], v[64:67]
    v_exp_f32 v42, v42
    v_mfma_f32_16x16x32_bf16 v[68:71], a[128:131], v[176:179], 0
    v_exp_f32 v43, v43
    v_mfma_f32_16x16x32_bf16 v[68:71], a[132:135], v[180:183], v[68:71]
    ds_read_b128 a[152:155], v4 offset:12288
    ds_read_b128 a[156:159], v5 offset:12288
    v_mfma_f32_16x16x32_bf16 v[68:71], a[136:139], v[184:187], v[68:71]
    s_sub_u32 s93, s91, s90
    buffer_load_dwordx4 v15, s[24:27], s55 offen offset:1024  lds
    v_mfma_f32_16x16x32_bf16 v[68:71], a[140:143], v[188:191], v[68:71]
    v_exp_f32 v44, v44
    v_mfma_f32_16x16x32_bf16 v[72:75], a[128:131], v[192:195], 0
    s_mov_b32 s60, s90
    s_mov_b32 s90, s91
    s_mov_b32 s91, s92
    s_mov_b32 s92, s60
    v_exp_f32 v45, v45
    v_mfma_f32_16x16x32_bf16 v[72:75], a[132:135], v[196:199], v[72:75]
    v_add_u32 v2, s93, v2
    v_add_u32 v3, s93, v3
    v_mfma_f32_16x16x32_bf16 v[72:75], a[136:139], v[200:203], v[72:75]
    buffer_load_dwordx4 v14, s[24:27], s55 offen offset:2048  lds
    v_mfma_f32_16x16x32_bf16 v[72:75], a[140:143], v[204:207], v[72:75]
    v_add_u32 v4, s93, v4
    v_add_u32 v5, s93, v5
    v_mfma_f32_16x16x32_bf16 v[76:79], a[128:131], v[208:211], 0
    v_exp_f32 v46, v46
    v_mfma_f32_16x16x32_bf16 v[76:79], a[132:135], v[212:215], v[76:79]
    v_mfma_f32_16x16x32_bf16 v[76:79], a[136:139], v[216:219], v[76:79]
    buffer_load_dwordx4 v15, s[24:27], s55 offen offset:3072  lds
    v_mfma_f32_16x16x32_bf16 v[76:79], a[140:143], v[220:223], v[76:79]
    s_waitcnt lgkmcnt(0)
    v_exp_f32 v47, v47
    v_mfma_f32_16x16x32_bf16 v[80:83], a[144:147], v[160:163], 0
    v_exp_f32 v48, v48
    v_mfma_f32_16x16x32_bf16 v[80:83], a[148:151], v[164:167], v[80:83]
    s_add_u32 m0, s58, 65536
    ds_read_b64_tr_b16 a[160:161], v6 offset:0
    ds_read_b64_tr_b16 a[162:163], v6 offset:4096
    v_mfma_f32_16x16x32_bf16 v[80:83], a[152:155], v[168:171], v[80:83]
    buffer_load_dwordx4 v14, s[28:31], s56 offen offset:0  lds
    v_mfma_f32_16x16x32_bf16 v[80:83], a[156:159], v[172:175], v[80:83]
    v_cvt_pk_bf16_f32 v145, v42, v43
    v_cvt_pk_bf16_f32 v152, v44, v45
    v_mfma_f32_16x16x32_bf16 v[84:87], a[144:147], v[176:179], 0
    v_exp_f32 v49, v49
    v_mfma_f32_16x16x32_bf16 v[84:87], a[148:151], v[180:183], v[84:87]
    ds_read_b64_tr_b16 a[164:165], v6 offset:8192
    ds_read_b64_tr_b16 a[166:167], v6 offset:12288
    v_mfma_f32_16x16x32_bf16 v[84:87], a[152:155], v[184:187], v[84:87]
    buffer_load_dwordx4 v15, s[28:31], s56 offen offset:1024  lds
    v_mfma_f32_16x16x32_bf16 v[84:87], a[156:159], v[188:191], v[84:87]
    v_exp_f32 v50, v50
    v_mfma_f32_16x16x32_bf16 v[88:91], a[144:147], v[192:195], 0
    v_exp_f32 v51, v51
    v_mfma_f32_16x16x32_bf16 v[88:91], a[148:151], v[196:199], v[88:91]
    ds_read_b64_tr_b16 a[168:169], v7 offset:0
    ds_read_b64_tr_b16 a[170:171], v7 offset:4096
    v_mfma_f32_16x16x32_bf16 v[88:91], a[152:155], v[200:203], v[88:91]
    buffer_load_dwordx4 v14, s[28:31], s56 offen offset:2048  lds
    v_mfma_f32_16x16x32_bf16 v[88:91], a[156:159], v[204:207], v[88:91]
    v_exp_f32 v52, v52
    v_mfma_f32_16x16x32_bf16 v[92:95], a[144:147], v[208:211], 0
    v_cvt_pk_bf16_f32 v153, v46, v47
    v_cvt_pk_bf16_f32 v130, v48, v49
    v_mfma_f32_16x16x32_bf16 v[92:95], a[148:151], v[212:215], v[92:95]
    ds_read_b64_tr_b16 a[172:173], v7 offset:8192
    ds_read_b64_tr_b16 a[174:175], v7 offset:12288
    v_mfma_f32_16x16x32_bf16 v[92:95], a[152:155], v[216:219], v[92:95]
    buffer_load_dwordx4 v15, s[28:31], s56 offen offset:3072  lds
    v_mfma_f32_16x16x32_bf16 v[92:95], a[156:159], v[220:223], v[92:95]
    s_add_u32 s55, s55, 16384
    s_min_u32 s55, s55, 507904
    s_waitcnt lgkmcnt(4)
    v_exp_f32 v53, v53
    v_mfma_f32_16x16x32_bf16 a[0:3], a[160:163], v[96:99], a[0:3]
    s_add_u32 s56, s56, 16384
    v_exp_f32 v54, v54
    v_mfma_f32_16x16x32_bf16 a[0:3], a[164:167], v[100:103], a[0:3]
    s_mov_b32 m0, 160768
    ds_read_b64_tr_b16 a[176:177], v8 offset:0
    ds_read_b64_tr_b16 a[178:179], v8 offset:4096
    v_mfma_f32_16x16x32_bf16 a[4:7], a[160:163], v[104:107], a[4:7]
    buffer_load_dwordx4 v249, s[24:27], s68 offen  lds
    v_mfma_f32_16x16x32_bf16 a[4:7], a[164:167], v[108:111], a[4:7]
    v_exp_f32 v55, v55
    v_mfma_f32_16x16x32_bf16 a[8:11], a[160:163], v[112:115], a[8:11]
    buffer_load_dwordx4 v246, s[40:43], s69 offen  lds
    v_mfma_f32_16x16x32_bf16 a[8:11], a[164:167], v[116:119], a[8:11]
    ds_read_b64_tr_b16 a[180:181], v8 offset:8192
    ds_read_b64_tr_b16 a[182:183], v8 offset:12288
    v_mfma_f32_16x16x32_bf16 a[12:15], a[160:163], v[120:123], a[12:15]
    v_exp_f32 v56, v56
    v_mfma_f32_16x16x32_bf16 a[12:15], a[164:167], v[124:127], a[12:15]
    v_cvt_pk_bf16_f32 v131, v50, v51
    v_cvt_pk_bf16_f32 v138, v52, v53
    v_smfmac_f32_16x16x64_bf16 a[184:187], a[200:203], v[96:103], v18
    s_waitcnt lgkmcnt(4)
    v_exp_f32 v57, v57
    v_mfma_f32_16x16x32_bf16 a[16:19], a[168:171], v[96:99], a[16:19]
    v_exp_f32 v58, v58
    v_mfma_f32_16x16x32_bf16 a[16:19], a[172:175], v[100:103], a[16:19]
    ds_read_b64_tr_b16 a[160:161], v9 offset:0
    ds_read_b64_tr_b16 a[162:163], v9 offset:4096
    v_mfma_f32_16x16x32_bf16 a[20:23], a[168:171], v[104:107], a[20:23]
    v_exp_f32 v59, v59
    v_mfma_f32_16x16x32_bf16 a[20:23], a[172:175], v[108:111], a[20:23]
    ds_read_b64_tr_b16 a[164:165], v9 offset:8192
    ds_read_b64_tr_b16 a[166:167], v9 offset:12288
    v_mfma_f32_16x16x32_bf16 a[24:27], a[168:171], v[112:115], a[24:27]
    v_exp_f32 v60, v60
    v_mfma_f32_16x16x32_bf16 a[24:27], a[172:175], v[116:119], a[24:27]
    v_exp_f32 v61, v61
    v_mfma_f32_16x16x32_bf16 a[28:31], a[168:171], v[120:123], a[28:31]
    v_cvt_pk_bf16_f32 v139, v54, v55
    v_cvt_pk_bf16_f32 v146, v56, v57
    v_mfma_f32_16x16x32_bf16 a[28:31], a[172:175], v[124:127], a[28:31]
    v_exp_f32 v62, v62
    v_smfmac_f32_16x16x64_bf16 a[188:191], a[200:203], v[104:111], v18
    s_waitcnt lgkmcnt(4)
    v_cvt_pk_bf16_f32 v147, v58, v59
    v_cvt_pk_bf16_f32 v154, v60, v61
    v_mfma_f32_16x16x32_bf16 a[32:35], a[176:179], v[96:99], a[32:35]
    v_exp_f32 v63, v63
    v_mfma_f32_16x16x32_bf16 a[32:35], a[180:183], v[100:103], a[32:35]
    ds_read_b64_tr_b16 a[168:169], v10 offset:0
    ds_read_b64_tr_b16 a[170:171], v10 offset:4096
    v_mfma_f32_16x16x32_bf16 a[36:39], a[176:179], v[104:107], a[36:39]
    v_exp_f32 v64, v64
    v_mfma_f32_16x16x32_bf16 a[36:39], a[180:183], v[108:111], a[36:39]
    v_exp_f32 v65, v65
    v_mfma_f32_16x16x32_bf16 a[40:43], a[176:179], v[112:115], a[40:43]
    ds_read_b64_tr_b16 a[172:173], v10 offset:8192
    ds_read_b64_tr_b16 a[174:175], v10 offset:12288
    v_mfma_f32_16x16x32_bf16 a[40:43], a[180:183], v[116:119], a[40:43]
    v_exp_f32 v66, v66
    v_mfma_f32_16x16x32_bf16 a[44:47], a[176:179], v[120:123], a[44:47]
    v_cvt_pk_bf16_f32 v155, v62, v63
    v_cvt_pk_bf16_f32 v132, v64, v65
    v_mfma_f32_16x16x32_bf16 a[44:47], a[180:183], v[124:127], a[44:47]
    v_exp_f32 v67, v67
    v_smfmac_f32_16x16x64_bf16 a[192:195], a[200:203], v[112:119], v18
    s_waitcnt lgkmcnt(4)
    v_exp_f32 v68, v68
    v_mfma_f32_16x16x32_bf16 a[48:51], a[160:163], v[96:99], a[48:51]
    ds_read_b64_tr_b16 a[176:177], v11 offset:0
    ds_read_b64_tr_b16 a[178:179], v11 offset:4096
    v_mfma_f32_16x16x32_bf16 a[48:51], a[164:167], v[100:103], a[48:51]
    v_exp_f32 v69, v69
    v_mfma_f32_16x16x32_bf16 a[52:55], a[160:163], v[104:107], a[52:55]
    ds_read_b64_tr_b16 a[180:181], v11 offset:8192
    ds_read_b64_tr_b16 a[182:183], v11 offset:12288
    v_mfma_f32_16x16x32_bf16 a[52:55], a[164:167], v[108:111], a[52:55]
    v_exp_f32 v70, v70
    v_mfma_f32_16x16x32_bf16 a[56:59], a[160:163], v[112:115], a[56:59]
    v_cvt_pk_bf16_f32 v133, v66, v67
    v_cvt_pk_bf16_f32 v140, v68, v69
    v_mfma_f32_16x16x32_bf16 a[56:59], a[164:167], v[116:119], a[56:59]
    v_exp_f32 v71, v71
    v_mfma_f32_16x16x32_bf16 a[60:63], a[160:163], v[120:123], a[60:63]
    v_exp_f32 v72, v72
    v_mfma_f32_16x16x32_bf16 a[60:63], a[164:167], v[124:127], a[60:63]
    v_cvt_pk_bf16_f32 v141, v70, v71
    v_smfmac_f32_16x16x64_bf16 a[196:199], a[200:203], v[120:127], v18
    s_waitcnt lgkmcnt(4)
    v_exp_f32 v73, v73
    v_mfma_f32_16x16x32_bf16 a[64:67], a[168:171], v[96:99], a[64:67]
    ds_read_b64_tr_b16 a[160:161], v12 offset:0
    ds_read_b64_tr_b16 a[162:163], v12 offset:4096
    v_mfma_f32_16x16x32_bf16 a[64:67], a[172:175], v[100:103], a[64:67]
    v_exp_f32 v74, v74
    v_mfma_f32_16x16x32_bf16 a[68:71], a[168:171], v[104:107], a[68:71]
    v_exp_f32 v75, v75
    v_mfma_f32_16x16x32_bf16 a[68:71], a[172:175], v[108:111], a[68:71]
    ds_read_b64_tr_b16 a[164:165], v12 offset:8192
    ds_read_b64_tr_b16 a[166:167], v12 offset:12288
    v_mfma_f32_16x16x32_bf16 a[72:75], a[168:171], v[112:115], a[72:75]
    v_exp_f32 v76, v76
    v_mfma_f32_16x16x32_bf16 a[72:75], a[172:175], v[116:119], a[72:75]
    ds_read_b128 a[128:131], v2 offset:0
    ds_read_b128 a[132:135], v3 offset:0
    v_mfma_f32_16x16x32_bf16 a[76:79], a[168:171], v[120:123], a[76:79]
    v_exp_f32 v77, v77
    v_mfma_f32_16x16x32_bf16 a[76:79], a[172:175], v[124:127], a[76:79]
    s_waitcnt lgkmcnt(6)
    ds_read_b128 a[136:139], v4 offset:0
    ds_read_b128 a[140:143], v5 offset:0
    v_mfma_f32_16x16x32_bf16 a[80:83], a[176:179], v[96:99], a[80:83]
    v_exp_f32 v78, v78
    v_mfma_f32_16x16x32_bf16 a[80:83], a[180:183], v[100:103], a[80:83]
    v_exp_f32 v79, v79
    v_mfma_f32_16x16x32_bf16 a[84:87], a[176:179], v[104:107], a[84:87]
    ds_read_b64_tr_b16 a[168:169], v13 offset:0
    ds_read_b64_tr_b16 a[170:171], v13 offset:4096
    v_mfma_f32_16x16x32_bf16 a[84:87], a[180:183], v[108:111], a[84:87]
    v_exp_f32 v80, v80
    v_mfma_f32_16x16x32_bf16 a[88:91], a[176:179], v[112:115], a[88:91]
    ds_read_b64_tr_b16 a[172:173], v13 offset:8192
    ds_read_b64_tr_b16 a[174:175], v13 offset:12288
    v_mfma_f32_16x16x32_bf16 a[88:91], a[180:183], v[116:119], a[88:91]
    v_exp_f32 v81, v81
    v_mfma_f32_16x16x32_bf16 a[92:95], a[176:179], v[120:123], a[92:95]
    v_exp_f32 v82, v82
    v_mfma_f32_16x16x32_bf16 a[92:95], a[180:183], v[124:127], a[92:95]
    s_waitcnt lgkmcnt(8)
    v_add_u32 v248, 1, v248
    v_cvt_pk_bf16_f32 v148, v72, v73
    v_mfma_f32_16x16x32_bf16 a[96:99], a[160:163], v[96:99], a[96:99]
    v_exp_f32 v83, v83
    v_mfma_f32_16x16x32_bf16 a[96:99], a[164:167], v[100:103], a[96:99]
    v_exp_f32 v84, v84
    v_mfma_f32_16x16x32_bf16 a[100:103], a[160:163], v[104:107], a[100:103]
    s_waitcnt vmcnt(2) lgkmcnt(0)
    ds_write_b32 v255, v248
    v_cvt_pk_bf16_f32 v149, v74, v75
    v_mfma_f32_16x16x32_bf16 a[100:103], a[164:167], v[108:111], a[100:103]
    v_cvt_pk_bf16_f32 v156, v76, v77
    v_cvt_pk_bf16_f32 v157, v78, v79
    v_mfma_f32_16x16x32_bf16 a[104:107], a[160:163], v[112:115], a[104:107]
    v_exp_f32 v85, v85
    v_mfma_f32_16x16x32_bf16 a[104:107], a[164:167], v[116:119], a[104:107]
    v_exp_f32 v86, v86
    v_mfma_f32_16x16x32_bf16 a[108:111], a[160:163], v[120:123], a[108:111]
    v_cvt_pk_bf16_f32 v134, v80, v81
    v_cvt_pk_bf16_f32 v135, v82, v83
    v_mfma_f32_16x16x32_bf16 a[108:111], a[164:167], v[124:127], a[108:111]
    v_exp_f32 v87, v87
    v_mfma_f32_16x16x32_bf16 a[112:115], a[168:171], v[96:99], a[112:115]
    v_cvt_pk_bf16_f32 v142, v84, v85
    v_cvt_pk_bf16_f32 v143, v86, v87
    v_mfma_f32_16x16x32_bf16 a[112:115], a[172:175], v[100:103], a[112:115]
    v_exp_f32 v88, v88
    v_mfma_f32_16x16x32_bf16 a[116:119], a[168:171], v[104:107], a[116:119]
    v_exp_f32 v89, v89
    v_mfma_f32_16x16x32_bf16 a[116:119], a[172:175], v[108:111], a[116:119]
    v_cvt_pk_bf16_f32 v150, v88, v89
    v_mfma_f32_16x16x32_bf16 a[120:123], a[168:171], v[112:115], a[120:123]
    v_exp_f32 v90, v90
    v_mfma_f32_16x16x32_bf16 a[120:123], a[172:175], v[116:119], a[120:123]
    v_mfma_f32_16x16x32_bf16 a[124:127], a[168:171], v[120:123], a[124:127]
    v_exp_f32 v91, v91
    v_mfma_f32_16x16x32_bf16 a[124:127], a[172:175], v[124:127], a[124:127]
    s_bitcmp1_b32 s94, s57
    v_exp_f32 v92, v92
    s_cbranch_scc1 L_drain_standalone__tree_speculative_verify_tree_attention_over_candidate_token_tree__prompt_kernel
    s_waitcnt lgkmcnt(0)
    v_mfma_f32_16x16x32_bf16 v[32:35], a[128:131], v[160:163], 0
    s_add_u32 s57, s57, 1
    v_exp_f32 v93, v93
    v_mfma_f32_16x16x32_bf16 v[32:35], a[132:135], v[164:167], v[32:35]
    s_add_u32 m0, s78, 8192
    ds_read_b128 a[144:147], v2 offset:4096
    ds_read_b128 a[148:151], v3 offset:4096
    v_mfma_f32_16x16x32_bf16 v[32:35], a[136:139], v[168:171], v[32:35]
    buffer_load_dwordx4 v236, s[44:47], 0 offen  lds
    v_mfma_f32_16x16x32_bf16 v[32:35], a[140:143], v[172:175], v[32:35]
    v_exp_f32 v94, v94
    v_mfma_f32_16x16x32_bf16 v[36:39], a[128:131], v[176:179], 0
    v_cvt_pk_bf16_f32 v151, v90, v91
    v_cvt_pk_bf16_f32 v158, v92, v93
    v_mfma_f32_16x16x32_bf16 v[36:39], a[132:135], v[180:183], v[36:39]
    s_add_u32 m0, s78, 9216
    ds_read_b128 a[152:155], v4 offset:4096
    ds_read_b128 a[156:159], v5 offset:4096
    v_mfma_f32_16x16x32_bf16 v[36:39], a[136:139], v[184:187], v[36:39]
    buffer_load_dwordx4 v237, s[44:47], 0 offen  lds
    v_mfma_f32_16x16x32_bf16 v[36:39], a[140:143], v[188:191], v[36:39]
    v_exp_f32 v95, v95
    v_mfma_f32_16x16x32_bf16 v[40:43], a[128:131], v[192:195], 0
    v_exp_f32 v32, v32
    v_mfma_f32_16x16x32_bf16 v[40:43], a[132:135], v[196:199], v[40:43]
    s_add_u32 m0, s78, 10240
    ds_read_b128 a[204:207], v21 offset:0
    ds_read_b128 a[208:211], v22 offset:0
    v_mfma_f32_16x16x32_bf16 v[40:43], a[136:139], v[200:203], v[40:43]
    buffer_load_dwordx4 v238, s[44:47], 0 offen  lds
    v_mfma_f32_16x16x32_bf16 v[40:43], a[140:143], v[204:207], v[40:43]
    v_exp_f32 v33, v33
    v_mfma_f32_16x16x32_bf16 v[44:47], a[128:131], v[208:211], 0
    v_exp_f32 v34, v34
    v_mfma_f32_16x16x32_bf16 v[44:47], a[132:135], v[212:215], v[44:47]
    s_add_u32 m0, s78, 11264
    ds_read_b128 a[212:215], v23 offset:0
    ds_read_b128 a[216:219], v24 offset:0
    v_mfma_f32_16x16x32_bf16 v[44:47], a[136:139], v[216:219], v[44:47]
    buffer_load_dwordx4 v239, s[44:47], 0 offen  lds
    v_mfma_f32_16x16x32_bf16 v[44:47], a[140:143], v[220:223], v[44:47]
    s_waitcnt lgkmcnt(4)
    v_cvt_pk_bf16_f32 v96, v32, v33
    v_cvt_pk_bf16_f32 v159, v94, v95
    v_mfma_f32_16x16x32_bf16 v[48:51], a[144:147], v[160:163], 0
    v_exp_f32 v35, v35
    v_mfma_f32_16x16x32_bf16 v[48:51], a[148:151], v[164:167], v[48:51]
    s_add_u32 m0, s78, 12288
    ds_read_b32 v252, v253
    ds_read_b128 a[128:131], v2 offset:8192
    v_mfma_f32_16x16x32_bf16 v[48:51], a[152:155], v[168:171], v[48:51]
    buffer_load_dwordx4 v240, s[44:47], 0 offen  lds
    v_mfma_f32_16x16x32_bf16 v[48:51], a[156:159], v[172:175], v[48:51]
    v_exp_f32 v36, v36
    v_mfma_f32_16x16x32_bf16 v[52:55], a[144:147], v[176:179], 0
    v_exp_f32 v37, v37
    v_mfma_f32_16x16x32_bf16 v[52:55], a[148:151], v[180:183], v[52:55]
    s_add_u32 m0, s78, 13312
    ds_read_b128 a[132:135], v3 offset:8192
    ds_read_b128 a[136:139], v4 offset:8192
    v_mfma_f32_16x16x32_bf16 v[52:55], a[152:155], v[184:187], v[52:55]
    buffer_load_dwordx4 v241, s[44:47], 0 offen  lds
    v_mfma_f32_16x16x32_bf16 v[52:55], a[156:159], v[188:191], v[52:55]
    v_cvt_pk_bf16_f32 v97, v34, v35
    v_cvt_pk_bf16_f32 v104, v36, v37
    v_mfma_f32_16x16x32_bf16 v[56:59], a[144:147], v[192:195], 0
    v_exp_f32 v38, v38
    v_mfma_f32_16x16x32_bf16 v[56:59], a[148:151], v[196:199], v[56:59]
    s_add_u32 m0, s78, 14336
    ds_read_b128 a[140:143], v5 offset:8192
    ds_read_b128 a[220:223], v21 offset:4096
    v_mfma_f32_16x16x32_bf16 v[56:59], a[152:155], v[200:203], v[56:59]
    buffer_load_dwordx4 v242, s[44:47], 0 offen  lds
    v_mfma_f32_16x16x32_bf16 v[56:59], a[156:159], v[204:207], v[56:59]
    v_exp_f32 v39, v39
    v_mfma_f32_16x16x32_bf16 v[60:63], a[144:147], v[208:211], 0
    v_exp_f32 v40, v40
    v_mfma_f32_16x16x32_bf16 v[60:63], a[148:151], v[212:215], v[60:63]
    s_add_u32 m0, s78, 15360
    s_waitcnt lgkmcnt(5)
    ds_read_b128 a[224:227], v22 offset:4096
    v_cmp_gt_u32 vcc, v248, v252
    v_mfma_f32_16x16x32_bf16 v[60:63], a[152:155], v[216:219], v[60:63]
    s_cbranch_vccnz L_spind_standalone__tree_speculative_verify_tree_attention_over_candidate_token_tree__prompt_kernel
L_spinrd_standalone__tree_speculative_verify_tree_attention_over_candidate_token_tree__prompt_kernel:
    buffer_load_dwordx4 v243, s[44:47], 0 offen  lds
    v_mfma_f32_16x16x32_bf16 v[60:63], a[156:159], v[220:223], v[60:63]
    s_waitcnt lgkmcnt(2)
    v_exp_f32 v41, v41
    v_mfma_f32_16x16x32_bf16 v[64:67], a[128:131], v[160:163], 0
    v_cvt_pk_bf16_f32 v105, v38, v39
    v_cvt_pk_bf16_f32 v112, v40, v41
    v_mfma_f32_16x16x32_bf16 v[64:67], a[132:135], v[164:167], v[64:67]
    s_add_u32 m0, s58, s92
    ds_read_b128 a[144:147], v2 offset:12288
    ds_read_b128 a[148:151], v3 offset:12288
    v_mfma_f32_16x16x32_bf16 v[64:67], a[136:139], v[168:171], v[64:67]
    buffer_load_dwordx4 v14, s[24:27], s55 offen offset:0  lds
    v_mfma_f32_16x16x32_bf16 v[64:67], a[140:143], v[172:175], v[64:67]
    v_exp_f32 v42, v42
    v_mfma_f32_16x16x32_bf16 v[68:71], a[128:131], v[176:179], 0
    v_exp_f32 v43, v43
    v_mfma_f32_16x16x32_bf16 v[68:71], a[132:135], v[180:183], v[68:71]
    ds_read_b128 a[152:155], v4 offset:12288
    ds_read_b128 a[156:159], v5 offset:12288
    v_mfma_f32_16x16x32_bf16 v[68:71], a[136:139], v[184:187], v[68:71]
    s_sub_u32 s93, s91, s90
    buffer_load_dwordx4 v15, s[24:27], s55 offen offset:1024  lds
    v_mfma_f32_16x16x32_bf16 v[68:71], a[140:143], v[188:191], v[68:71]
    v_exp_f32 v44, v44
    v_mfma_f32_16x16x32_bf16 v[72:75], a[128:131], v[192:195], 0
    s_mov_b32 s60, s90
    s_mov_b32 s90, s91
    s_mov_b32 s91, s92
    s_mov_b32 s92, s60
    v_exp_f32 v45, v45
    v_mfma_f32_16x16x32_bf16 v[72:75], a[132:135], v[196:199], v[72:75]
    v_add_u32 v2, s93, v2
    v_add_u32 v3, s93, v3
    v_mfma_f32_16x16x32_bf16 v[72:75], a[136:139], v[200:203], v[72:75]
    buffer_load_dwordx4 v14, s[24:27], s55 offen offset:2048  lds
    v_mfma_f32_16x16x32_bf16 v[72:75], a[140:143], v[204:207], v[72:75]
    v_add_u32 v4, s93, v4
    v_add_u32 v5, s93, v5
    v_mfma_f32_16x16x32_bf16 v[76:79], a[128:131], v[208:211], 0
    v_exp_f32 v46, v46
    v_mfma_f32_16x16x32_bf16 v[76:79], a[132:135], v[212:215], v[76:79]
    ds_read_b128 a[228:231], v23 offset:4096
    ds_read_b128 a[232:235], v24 offset:4096
    v_mfma_f32_16x16x32_bf16 v[76:79], a[136:139], v[216:219], v[76:79]
    buffer_load_dwordx4 v15, s[24:27], s55 offen offset:3072  lds
    v_mfma_f32_16x16x32_bf16 v[76:79], a[140:143], v[220:223], v[76:79]
    s_waitcnt lgkmcnt(2)
    v_exp_f32 v47, v47
    v_mfma_f32_16x16x32_bf16 v[80:83], a[144:147], v[160:163], 0
    v_exp_f32 v48, v48
    v_mfma_f32_16x16x32_bf16 v[80:83], a[148:151], v[164:167], v[80:83]
    s_add_u32 m0, s58, 49152
    ds_read_b64_tr_b16 a[160:161], v6 offset:16384
    ds_read_b64_tr_b16 a[162:163], v6 offset:20480
    v_mfma_f32_16x16x32_bf16 v[80:83], a[152:155], v[168:171], v[80:83]
    buffer_load_dwordx4 v14, s[28:31], s56 offen offset:0  lds
    v_mfma_f32_16x16x32_bf16 v[80:83], a[156:159], v[172:175], v[80:83]
    v_cvt_pk_bf16_f32 v113, v42, v43
    v_cvt_pk_bf16_f32 v120, v44, v45
    v_mfma_f32_16x16x32_bf16 v[84:87], a[144:147], v[176:179], 0
    v_exp_f32 v49, v49
    v_mfma_f32_16x16x32_bf16 v[84:87], a[148:151], v[180:183], v[84:87]
    ds_read_b64_tr_b16 a[164:165], v6 offset:24576
    ds_read_b64_tr_b16 a[166:167], v6 offset:28672
    v_mfma_f32_16x16x32_bf16 v[84:87], a[152:155], v[184:187], v[84:87]
    buffer_load_dwordx4 v15, s[28:31], s56 offen offset:1024  lds
    v_mfma_f32_16x16x32_bf16 v[84:87], a[156:159], v[188:191], v[84:87]
    v_exp_f32 v50, v50
    v_mfma_f32_16x16x32_bf16 v[88:91], a[144:147], v[192:195], 0
    v_exp_f32 v51, v51
    v_mfma_f32_16x16x32_bf16 v[88:91], a[148:151], v[196:199], v[88:91]
    ds_read_b64_tr_b16 a[168:169], v7 offset:16384
    ds_read_b64_tr_b16 a[170:171], v7 offset:20480
    v_mfma_f32_16x16x32_bf16 v[88:91], a[152:155], v[200:203], v[88:91]
    buffer_load_dwordx4 v14, s[28:31], s56 offen offset:2048  lds
    v_mfma_f32_16x16x32_bf16 v[88:91], a[156:159], v[204:207], v[88:91]
    v_exp_f32 v52, v52
    v_mfma_f32_16x16x32_bf16 v[92:95], a[144:147], v[208:211], 0
    v_cvt_pk_bf16_f32 v121, v46, v47
    v_cvt_pk_bf16_f32 v98, v48, v49
    v_mfma_f32_16x16x32_bf16 v[92:95], a[148:151], v[212:215], v[92:95]
    ds_read_b64_tr_b16 a[172:173], v7 offset:24576
    ds_read_b64_tr_b16 a[174:175], v7 offset:28672
    v_mfma_f32_16x16x32_bf16 v[92:95], a[152:155], v[216:219], v[92:95]
    buffer_load_dwordx4 v15, s[28:31], s56 offen offset:3072  lds
    v_mfma_f32_16x16x32_bf16 v[92:95], a[156:159], v[220:223], v[92:95]
    s_add_u32 s55, s55, 16384
    s_min_u32 s55, s55, 507904
    s_waitcnt lgkmcnt(4)
    v_exp_f32 v53, v53
    v_mfma_f32_16x16x32_bf16 a[0:3], a[160:163], v[128:131], a[0:3]
    s_add_u32 s56, s56, 16384
    v_exp_f32 v54, v54
    v_mfma_f32_16x16x32_bf16 a[0:3], a[164:167], v[132:135], a[0:3]
    s_mov_b32 m0, 160768
    ds_read_b64_tr_b16 a[176:177], v8 offset:16384
    ds_read_b64_tr_b16 a[178:179], v8 offset:20480
    v_mfma_f32_16x16x32_bf16 a[4:7], a[160:163], v[136:139], a[4:7]
    buffer_load_dwordx4 v249, s[28:31], s68 offen  lds
    v_mfma_f32_16x16x32_bf16 a[4:7], a[164:167], v[140:143], a[4:7]
    s_add_u32 s68, s68, 32768
    v_exp_f32 v55, v55
    v_mfma_f32_16x16x32_bf16 a[8:11], a[160:163], v[144:147], a[8:11]
    buffer_load_dwordx4 v246, s[44:47], s69 offen  lds
    v_mfma_f32_16x16x32_bf16 a[8:11], a[164:167], v[148:151], a[8:11]
    s_add_u32 s69, s69, 65536
    ds_read_b64_tr_b16 a[180:181], v8 offset:24576
    ds_read_b64_tr_b16 a[182:183], v8 offset:28672
    v_mfma_f32_16x16x32_bf16 a[12:15], a[160:163], v[152:155], a[12:15]
    v_exp_f32 v56, v56
    v_mfma_f32_16x16x32_bf16 a[12:15], a[164:167], v[156:159], a[12:15]
    v_cvt_pk_bf16_f32 v99, v50, v51
    v_cvt_pk_bf16_f32 v106, v52, v53
    v_smfmac_f32_16x16x64_bf16 a[184:187], a[200:203], v[128:135], v18
    s_waitcnt lgkmcnt(4)
    v_exp_f32 v57, v57
    v_mfma_f32_16x16x32_bf16 a[16:19], a[168:171], v[128:131], a[16:19]
    v_exp_f32 v58, v58
    v_mfma_f32_16x16x32_bf16 a[16:19], a[172:175], v[132:135], a[16:19]
    ds_read_b64_tr_b16 a[160:161], v9 offset:16384
    ds_read_b64_tr_b16 a[162:163], v9 offset:20480
    v_mfma_f32_16x16x32_bf16 a[20:23], a[168:171], v[136:139], a[20:23]
    v_exp_f32 v59, v59
    v_mfma_f32_16x16x32_bf16 a[20:23], a[172:175], v[140:143], a[20:23]
    ds_read_b64_tr_b16 a[164:165], v9 offset:24576
    ds_read_b64_tr_b16 a[166:167], v9 offset:28672
    v_mfma_f32_16x16x32_bf16 a[24:27], a[168:171], v[144:147], a[24:27]
    v_exp_f32 v60, v60
    v_mfma_f32_16x16x32_bf16 a[24:27], a[172:175], v[148:151], a[24:27]
    v_exp_f32 v61, v61
    v_mfma_f32_16x16x32_bf16 a[28:31], a[168:171], v[152:155], a[28:31]
    v_cvt_pk_bf16_f32 v107, v54, v55
    v_cvt_pk_bf16_f32 v114, v56, v57
    v_mfma_f32_16x16x32_bf16 a[28:31], a[172:175], v[156:159], a[28:31]
    v_exp_f32 v62, v62
    v_smfmac_f32_16x16x64_bf16 a[188:191], a[200:203], v[136:143], v18
    s_waitcnt lgkmcnt(4)
    v_cvt_pk_bf16_f32 v115, v58, v59
    v_cvt_pk_bf16_f32 v122, v60, v61
    v_mfma_f32_16x16x32_bf16 a[32:35], a[176:179], v[128:131], a[32:35]
    v_exp_f32 v63, v63
    v_mfma_f32_16x16x32_bf16 a[32:35], a[180:183], v[132:135], a[32:35]
    ds_read_b64_tr_b16 a[168:169], v10 offset:16384
    ds_read_b64_tr_b16 a[170:171], v10 offset:20480
    v_mfma_f32_16x16x32_bf16 a[36:39], a[176:179], v[136:139], a[36:39]
    v_exp_f32 v64, v64
    v_mfma_f32_16x16x32_bf16 a[36:39], a[180:183], v[140:143], a[36:39]
    v_exp_f32 v65, v65
    v_mfma_f32_16x16x32_bf16 a[40:43], a[176:179], v[144:147], a[40:43]
    ds_read_b64_tr_b16 a[172:173], v10 offset:24576
    ds_read_b64_tr_b16 a[174:175], v10 offset:28672
    v_mfma_f32_16x16x32_bf16 a[40:43], a[180:183], v[148:151], a[40:43]
    v_exp_f32 v66, v66
    v_mfma_f32_16x16x32_bf16 a[44:47], a[176:179], v[152:155], a[44:47]
    v_cvt_pk_bf16_f32 v123, v62, v63
    v_cvt_pk_bf16_f32 v100, v64, v65
    v_mfma_f32_16x16x32_bf16 a[44:47], a[180:183], v[156:159], a[44:47]
    v_exp_f32 v67, v67
    v_smfmac_f32_16x16x64_bf16 a[192:195], a[200:203], v[144:151], v18
    s_waitcnt lgkmcnt(4)
    v_exp_f32 v68, v68
    v_mfma_f32_16x16x32_bf16 a[48:51], a[160:163], v[128:131], a[48:51]
    ds_read_b64_tr_b16 a[176:177], v11 offset:16384
    ds_read_b64_tr_b16 a[178:179], v11 offset:20480
    v_mfma_f32_16x16x32_bf16 a[48:51], a[164:167], v[132:135], a[48:51]
    v_exp_f32 v69, v69
    v_mfma_f32_16x16x32_bf16 a[52:55], a[160:163], v[136:139], a[52:55]
    ds_read_b64_tr_b16 a[180:181], v11 offset:24576
    ds_read_b64_tr_b16 a[182:183], v11 offset:28672
    v_mfma_f32_16x16x32_bf16 a[52:55], a[164:167], v[140:143], a[52:55]
    v_exp_f32 v70, v70
    v_mfma_f32_16x16x32_bf16 a[56:59], a[160:163], v[144:147], a[56:59]
    v_cvt_pk_bf16_f32 v101, v66, v67
    v_cvt_pk_bf16_f32 v108, v68, v69
    v_mfma_f32_16x16x32_bf16 a[56:59], a[164:167], v[148:151], a[56:59]
    v_exp_f32 v71, v71
    v_mfma_f32_16x16x32_bf16 a[60:63], a[160:163], v[152:155], a[60:63]
    v_exp_f32 v72, v72
    v_mfma_f32_16x16x32_bf16 a[60:63], a[164:167], v[156:159], a[60:63]
    v_cvt_pk_bf16_f32 v109, v70, v71
    v_smfmac_f32_16x16x64_bf16 a[196:199], a[200:203], v[152:159], v18
    s_waitcnt lgkmcnt(4)
    v_exp_f32 v73, v73
    v_mfma_f32_16x16x32_bf16 a[64:67], a[168:171], v[128:131], a[64:67]
    ds_read_b64_tr_b16 a[160:161], v12 offset:16384
    ds_read_b64_tr_b16 a[162:163], v12 offset:20480
    v_mfma_f32_16x16x32_bf16 a[64:67], a[172:175], v[132:135], a[64:67]
    v_exp_f32 v74, v74
    v_mfma_f32_16x16x32_bf16 a[68:71], a[168:171], v[136:139], a[68:71]
    v_exp_f32 v75, v75
    v_mfma_f32_16x16x32_bf16 a[68:71], a[172:175], v[140:143], a[68:71]
    ds_read_b64_tr_b16 a[164:165], v12 offset:24576
    ds_read_b64_tr_b16 a[166:167], v12 offset:28672
    v_mfma_f32_16x16x32_bf16 a[72:75], a[168:171], v[144:147], a[72:75]
    v_exp_f32 v76, v76
    v_mfma_f32_16x16x32_bf16 a[72:75], a[172:175], v[148:151], a[72:75]
    ds_read_b128 a[128:131], v2 offset:0
    ds_read_b128 a[132:135], v3 offset:0
    v_mfma_f32_16x16x32_bf16 a[76:79], a[168:171], v[152:155], a[76:79]
    v_exp_f32 v77, v77
    v_mfma_f32_16x16x32_bf16 a[76:79], a[172:175], v[156:159], a[76:79]
    s_waitcnt lgkmcnt(6)
    ds_read_b128 a[136:139], v4 offset:0
    ds_read_b128 a[140:143], v5 offset:0
    v_mfma_f32_16x16x32_bf16 a[80:83], a[176:179], v[128:131], a[80:83]
    v_exp_f32 v78, v78
    v_mfma_f32_16x16x32_bf16 a[80:83], a[180:183], v[132:135], a[80:83]
    v_exp_f32 v79, v79
    v_mfma_f32_16x16x32_bf16 a[84:87], a[176:179], v[136:139], a[84:87]
    ds_read_b64_tr_b16 a[168:169], v13 offset:16384
    ds_read_b64_tr_b16 a[170:171], v13 offset:20480
    v_mfma_f32_16x16x32_bf16 a[84:87], a[180:183], v[140:143], a[84:87]
    v_exp_f32 v80, v80
    v_mfma_f32_16x16x32_bf16 a[88:91], a[176:179], v[144:147], a[88:91]
    ds_read_b64_tr_b16 a[172:173], v13 offset:24576
    ds_read_b64_tr_b16 a[174:175], v13 offset:28672
    v_mfma_f32_16x16x32_bf16 a[88:91], a[180:183], v[148:151], a[88:91]
    v_exp_f32 v81, v81
    v_mfma_f32_16x16x32_bf16 a[92:95], a[176:179], v[152:155], a[92:95]
    v_exp_f32 v82, v82
    v_mfma_f32_16x16x32_bf16 a[92:95], a[180:183], v[156:159], a[92:95]
    s_waitcnt lgkmcnt(8)
    v_add_u32 v248, 1, v248
    v_cvt_pk_bf16_f32 v116, v72, v73
    v_mfma_f32_16x16x32_bf16 a[96:99], a[160:163], v[128:131], a[96:99]
    v_exp_f32 v83, v83
    v_mfma_f32_16x16x32_bf16 a[96:99], a[164:167], v[132:135], a[96:99]
    v_exp_f32 v84, v84
    v_mfma_f32_16x16x32_bf16 a[100:103], a[160:163], v[136:139], a[100:103]
    s_waitcnt vmcnt(2) lgkmcnt(0)
    ds_write_b32 v255, v248
    v_cvt_pk_bf16_f32 v117, v74, v75
    v_mfma_f32_16x16x32_bf16 a[100:103], a[164:167], v[140:143], a[100:103]
    v_cvt_pk_bf16_f32 v124, v76, v77
    v_cvt_pk_bf16_f32 v125, v78, v79
    v_mfma_f32_16x16x32_bf16 a[104:107], a[160:163], v[144:147], a[104:107]
    v_exp_f32 v85, v85
    v_mfma_f32_16x16x32_bf16 a[104:107], a[164:167], v[148:151], a[104:107]
    v_exp_f32 v86, v86
    v_mfma_f32_16x16x32_bf16 a[108:111], a[160:163], v[152:155], a[108:111]
    v_cvt_pk_bf16_f32 v102, v80, v81
    v_cvt_pk_bf16_f32 v103, v82, v83
    v_mfma_f32_16x16x32_bf16 a[108:111], a[164:167], v[156:159], a[108:111]
    v_exp_f32 v87, v87
    v_mfma_f32_16x16x32_bf16 a[112:115], a[168:171], v[128:131], a[112:115]
    v_cvt_pk_bf16_f32 v110, v84, v85
    v_cvt_pk_bf16_f32 v111, v86, v87
    v_mfma_f32_16x16x32_bf16 a[112:115], a[172:175], v[132:135], a[112:115]
    v_exp_f32 v88, v88
    v_mfma_f32_16x16x32_bf16 a[116:119], a[168:171], v[136:139], a[116:119]
    v_exp_f32 v89, v89
    v_mfma_f32_16x16x32_bf16 a[116:119], a[172:175], v[140:143], a[116:119]
    v_cvt_pk_bf16_f32 v118, v88, v89
    v_mfma_f32_16x16x32_bf16 a[120:123], a[168:171], v[144:147], a[120:123]
    v_exp_f32 v90, v90
    v_mfma_f32_16x16x32_bf16 a[120:123], a[172:175], v[148:151], a[120:123]
    v_mfma_f32_16x16x32_bf16 a[124:127], a[168:171], v[152:155], a[124:127]
    v_exp_f32 v91, v91
    v_mfma_f32_16x16x32_bf16 a[124:127], a[172:175], v[156:159], a[124:127]
    v_exp_f32 v92, v92
L_disp_standalone__tree_speculative_verify_tree_attention_over_candidate_token_tree__prompt_kernel:
    s_cmp_eq_u32 s97, 0
    s_cbranch_scc1 L_sub0_standalone__tree_speculative_verify_tree_attention_over_candidate_token_tree__prompt_kernel
    s_cmp_eq_u32 s97, 1
    s_cbranch_scc1 L_sub1_standalone__tree_speculative_verify_tree_attention_over_candidate_token_tree__prompt_kernel
    s_cmp_eq_u32 s97, 2
    s_cbranch_scc1 L_sub2_standalone__tree_speculative_verify_tree_attention_over_candidate_token_tree__prompt_kernel
L_sub3_standalone__tree_speculative_verify_tree_attention_over_candidate_token_tree__prompt_kernel:
    s_waitcnt lgkmcnt(0)
    v_mfma_f32_16x16x32_bf16 v[32:35], a[204:207], v[208:211], 0
    s_mov_b32 s82, s83
    s_mov_b32 s80, s81
    s_ff1_i32_b32 s83, s76
    ds_read_b64_tr_b16 a[160:161], v25 offset:8192
    ds_read_b64_tr_b16 a[162:163], v25 offset:12288
    v_mfma_f32_16x16x32_bf16 v[32:35], a[208:211], v[212:215], v[32:35]
    s_min_u32 s83, s83, 32
    s_add_u32 s62, s76, -1
    s_and_b32 s76, s76, s62
    ds_read_b64_tr_b16 a[164:165], v26 offset:8192
    ds_read_b64_tr_b16 a[166:167], v26 offset:12288
    v_mfma_f32_16x16x32_bf16 v[32:35], a[212:215], v[216:219], v[32:35]
    s_and_b32 s60, s83, 3
    s_lshl_b32 s60, s60, 17
    s_lshr_b32 s61, s83, 2
    ds_read_b64_tr_b16 a[168:169], v27 offset:8192
    ds_read_b64_tr_b16 a[170:171], v27 offset:12288
    v_mfma_f32_16x16x32_bf16 v[32:35], a[216:219], v[220:223], v[32:35]
    s_and_b32 s61, s61, 7
    s_lshl_b32 s61, s61, 11
    s_add_u32 s81, s60, s61
    ds_read_b64_tr_b16 a[172:173], v28 offset:8192
    ds_read_b64_tr_b16 a[174:175], v28 offset:12288
    v_mfma_f32_16x16x32_bf16 v[36:39], a[220:223], v[208:211], 0
    s_add_u32 s81, s81, s77
    s_and_b32 s97, s82, 3
    s_add_u32 s62, s57, 2
    ds_read_b64_tr_b16 a[176:177], v29 offset:8192
    ds_read_b64_tr_b16 a[178:179], v29 offset:12288
    v_mfma_f32_16x16x32_bf16 v[36:39], a[224:227], v[212:215], v[36:39]
    s_cmp_lt_u32 s82, 32
    s_cselect_b32 s79, 0, 0x80000000
    s_cselect_b32 s97, s97, 4
    ds_read_b64_tr_b16 a[180:181], v30 offset:8192
    ds_read_b64_tr_b16 a[182:183], v30 offset:12288
    v_mfma_f32_16x16x32_bf16 v[36:39], a[228:231], v[216:219], v[36:39]
    s_cselect_b32 s62, s62, 31
    s_bitset1_b32 s94, s62
    ds_read_b64_tr_b16 a[236:237], v31 offset:8192
    ds_read_b64_tr_b16 a[238:239], v31 offset:12288
    v_mfma_f32_16x16x32_bf16 v[36:39], a[232:235], v[220:223], v[36:39]
    ds_read_b64_tr_b16 a[240:241], v0 offset:8192
    ds_read_b64_tr_b16 a[242:243], v0 offset:12288
    v_exp_f32 v32, v32
    v_exp_f32 v33, v33
    v_exp_f32 v34, v34
    v_exp_f32 v35, v35
    v_or3_b32 v236, v228, v16, s79
    v_cvt_pk_bf16_f32 v40, v32, v33
    v_cvt_pk_bf16_f32 v41, v34, v35
    v_or3_b32 v237, v229, v17, s79
    v_and_b32 v40, v40, v224
    v_and_b32 v41, v41, v225
    v_exp_f32 v36, v36
    v_exp_f32 v37, v37
    v_exp_f32 v38, v38
    v_exp_f32 v39, v39
    v_or3_b32 v238, v230, v16, s79
    v_cvt_pk_bf16_f32 v42, v36, v37
    v_cvt_pk_bf16_f32 v43, v38, v39
    v_or3_b32 v239, v231, v17, s79
    v_and_b32 v42, v42, v226
    v_and_b32 v43, v43, v227
    s_waitcnt lgkmcnt(0)
    s_nop 0
    v_mfma_f32_16x16x32_bf16 a[12:15], a[160:163], v[40:43], a[12:15]
    buffer_load_dwordx4 v[224:227], v20, s[48:51], s80 offen sc1
    v_mfma_f32_16x16x32_bf16 a[28:31], a[164:167], v[40:43], a[28:31]
    v_or3_b32 v240, v232, v16, s79
    v_or3_b32 v241, v233, v17, s79
    v_mfma_f32_16x16x32_bf16 a[44:47], a[168:171], v[40:43], a[44:47]
    v_or3_b32 v242, v234, v16, s79
    v_or3_b32 v243, v235, v17, s79
    v_mfma_f32_16x16x32_bf16 a[60:63], a[172:175], v[40:43], a[60:63]
    v_mfma_f32_16x16x32_bf16 a[76:79], a[176:179], v[40:43], a[76:79]
    buffer_load_dwordx4 v[228:231], v19, s[48:51], s81 offen offset:128 sc1
    v_mfma_f32_16x16x32_bf16 a[92:95], a[180:183], v[40:43], a[92:95]
    buffer_load_dwordx4 v[232:235], v19, s[48:51], s81 offen offset:144 sc1
    v_mfma_f32_16x16x32_bf16 a[108:111], a[236:239], v[40:43], a[108:111]
    v_mfma_f32_16x16x32_bf16 a[124:127], a[240:243], v[40:43], a[124:127]
    v_mfma_f32_16x16x32_bf16 a[196:199], a[248:251], v[40:43], a[196:199]
    s_cmp_lg_u32 s23, 0
    s_cbranch_scc1 L_drnext_standalone__tree_speculative_verify_tree_attention_over_candidate_token_tree__prompt_kernel
    s_cmp_lt_u32 s97, 4
    s_cbranch_scc1 L_loopB_standalone__tree_speculative_verify_tree_attention_over_candidate_token_tree__prompt_kernel
    s_branch L_loop_standalone__tree_speculative_verify_tree_attention_over_candidate_token_tree__prompt_kernel
L_sub0_standalone__tree_speculative_verify_tree_attention_over_candidate_token_tree__prompt_kernel:
    s_waitcnt lgkmcnt(0)
    v_mfma_f32_16x16x32_bf16 v[32:35], a[204:207], v[160:163], 0
    s_mov_b32 s82, s83
    s_mov_b32 s80, s81
    s_ff1_i32_b32 s83, s76
    ds_read_b64_tr_b16 a[160:161], v25 offset:8192
    ds_read_b64_tr_b16 a[162:163], v25 offset:12288
    v_mfma_f32_16x16x32_bf16 v[32:35], a[208:211], v[164:167], v[32:35]
    s_min_u32 s83, s83, 32
    s_add_u32 s62, s76, -1
    s_and_b32 s76, s76, s62
    ds_read_b64_tr_b16 a[164:165], v26 offset:8192
    ds_read_b64_tr_b16 a[166:167], v26 offset:12288
    v_mfma_f32_16x16x32_bf16 v[32:35], a[212:215], v[168:171], v[32:35]
    s_and_b32 s60, s83, 3
    s_lshl_b32 s60, s60, 17
    s_lshr_b32 s61, s83, 2
    ds_read_b64_tr_b16 a[168:169], v27 offset:8192
    ds_read_b64_tr_b16 a[170:171], v27 offset:12288
    v_mfma_f32_16x16x32_bf16 v[32:35], a[216:219], v[172:175], v[32:35]
    s_and_b32 s61, s61, 7
    s_lshl_b32 s61, s61, 11
    s_add_u32 s81, s60, s61
    ds_read_b64_tr_b16 a[172:173], v28 offset:8192
    ds_read_b64_tr_b16 a[174:175], v28 offset:12288
    v_mfma_f32_16x16x32_bf16 v[36:39], a[220:223], v[160:163], 0
    s_add_u32 s81, s81, s77
    s_and_b32 s97, s82, 3
    s_add_u32 s62, s57, 2
    ds_read_b64_tr_b16 a[176:177], v29 offset:8192
    ds_read_b64_tr_b16 a[178:179], v29 offset:12288
    v_mfma_f32_16x16x32_bf16 v[36:39], a[224:227], v[164:167], v[36:39]
    s_cmp_lt_u32 s82, 32
    s_cselect_b32 s79, 0, 0x80000000
    s_cselect_b32 s97, s97, 4
    ds_read_b64_tr_b16 a[180:181], v30 offset:8192
    ds_read_b64_tr_b16 a[182:183], v30 offset:12288
    v_mfma_f32_16x16x32_bf16 v[36:39], a[228:231], v[168:171], v[36:39]
    s_cselect_b32 s62, s62, 31
    s_bitset1_b32 s94, s62
    ds_read_b64_tr_b16 a[236:237], v31 offset:8192
    ds_read_b64_tr_b16 a[238:239], v31 offset:12288
    v_mfma_f32_16x16x32_bf16 v[36:39], a[232:235], v[172:175], v[36:39]
    ds_read_b64_tr_b16 a[240:241], v0 offset:8192
    ds_read_b64_tr_b16 a[242:243], v0 offset:12288
    v_exp_f32 v32, v32
    v_exp_f32 v33, v33
    v_exp_f32 v34, v34
    v_exp_f32 v35, v35
    v_or3_b32 v236, v228, v16, s79
    v_cvt_pk_bf16_f32 v40, v32, v33
    v_cvt_pk_bf16_f32 v41, v34, v35
    v_or3_b32 v237, v229, v17, s79
    v_and_b32 v40, v40, v224
    v_and_b32 v41, v41, v225
    v_exp_f32 v36, v36
    v_exp_f32 v37, v37
    v_exp_f32 v38, v38
    v_exp_f32 v39, v39
    v_or3_b32 v238, v230, v16, s79
    v_cvt_pk_bf16_f32 v42, v36, v37
    v_cvt_pk_bf16_f32 v43, v38, v39
    v_or3_b32 v239, v231, v17, s79
    v_and_b32 v42, v42, v226
    v_and_b32 v43, v43, v227
    s_waitcnt lgkmcnt(0)
    s_nop 0
    v_mfma_f32_16x16x32_bf16 a[0:3], a[160:163], v[40:43], a[0:3]
    buffer_load_dwordx4 v[224:227], v20, s[48:51], s80 offen sc1
    v_mfma_f32_16x16x32_bf16 a[16:19], a[164:167], v[40:43], a[16:19]
    v_or3_b32 v240, v232, v16, s79
    v_or3_b32 v241, v233, v17, s79
    v_mfma_f32_16x16x32_bf16 a[32:35], a[168:171], v[40:43], a[32:35]
    v_or3_b32 v242, v234, v16, s79
    v_or3_b32 v243, v235, v17, s79
    v_mfma_f32_16x16x32_bf16 a[48:51], a[172:175], v[40:43], a[48:51]
    v_mfma_f32_16x16x32_bf16 a[64:67], a[176:179], v[40:43], a[64:67]
    buffer_load_dwordx4 v[228:231], v19, s[48:51], s81 offen offset:128 sc1
    v_mfma_f32_16x16x32_bf16 a[80:83], a[180:183], v[40:43], a[80:83]
    buffer_load_dwordx4 v[232:235], v19, s[48:51], s81 offen offset:144 sc1
    v_mfma_f32_16x16x32_bf16 a[96:99], a[236:239], v[40:43], a[96:99]
    v_mfma_f32_16x16x32_bf16 a[112:115], a[240:243], v[40:43], a[112:115]
    v_mfma_f32_16x16x32_bf16 a[184:187], a[248:251], v[40:43], a[184:187]
    s_cmp_lg_u32 s23, 0
    s_cbranch_scc1 L_drnext_standalone__tree_speculative_verify_tree_attention_over_candidate_token_tree__prompt_kernel
    s_cmp_lt_u32 s97, 4
    s_cbranch_scc1 L_loopB_standalone__tree_speculative_verify_tree_attention_over_candidate_token_tree__prompt_kernel
    s_branch L_loop_standalone__tree_speculative_verify_tree_attention_over_candidate_token_tree__prompt_kernel
L_sub1_standalone__tree_speculative_verify_tree_attention_over_candidate_token_tree__prompt_kernel:
    s_waitcnt lgkmcnt(0)
    v_mfma_f32_16x16x32_bf16 v[32:35], a[204:207], v[176:179], 0
    s_mov_b32 s82, s83
    s_mov_b32 s80, s81
    s_ff1_i32_b32 s83, s76
    ds_read_b64_tr_b16 a[160:161], v25 offset:8192
    ds_read_b64_tr_b16 a[162:163], v25 offset:12288
    v_mfma_f32_16x16x32_bf16 v[32:35], a[208:211], v[180:183], v[32:35]
    s_min_u32 s83, s83, 32
    s_add_u32 s62, s76, -1
    s_and_b32 s76, s76, s62
    ds_read_b64_tr_b16 a[164:165], v26 offset:8192
    ds_read_b64_tr_b16 a[166:167], v26 offset:12288
    v_mfma_f32_16x16x32_bf16 v[32:35], a[212:215], v[184:187], v[32:35]
    s_and_b32 s60, s83, 3
    s_lshl_b32 s60, s60, 17
    s_lshr_b32 s61, s83, 2
    ds_read_b64_tr_b16 a[168:169], v27 offset:8192
    ds_read_b64_tr_b16 a[170:171], v27 offset:12288
    v_mfma_f32_16x16x32_bf16 v[32:35], a[216:219], v[188:191], v[32:35]
    s_and_b32 s61, s61, 7
    s_lshl_b32 s61, s61, 11
    s_add_u32 s81, s60, s61
    ds_read_b64_tr_b16 a[172:173], v28 offset:8192
    ds_read_b64_tr_b16 a[174:175], v28 offset:12288
    v_mfma_f32_16x16x32_bf16 v[36:39], a[220:223], v[176:179], 0
    s_add_u32 s81, s81, s77
    s_and_b32 s97, s82, 3
    s_add_u32 s62, s57, 2
    ds_read_b64_tr_b16 a[176:177], v29 offset:8192
    ds_read_b64_tr_b16 a[178:179], v29 offset:12288
    v_mfma_f32_16x16x32_bf16 v[36:39], a[224:227], v[180:183], v[36:39]
    s_cmp_lt_u32 s82, 32
    s_cselect_b32 s79, 0, 0x80000000
    s_cselect_b32 s97, s97, 4
    ds_read_b64_tr_b16 a[180:181], v30 offset:8192
    ds_read_b64_tr_b16 a[182:183], v30 offset:12288
    v_mfma_f32_16x16x32_bf16 v[36:39], a[228:231], v[184:187], v[36:39]
    s_cselect_b32 s62, s62, 31
    s_bitset1_b32 s94, s62
    ds_read_b64_tr_b16 a[236:237], v31 offset:8192
    ds_read_b64_tr_b16 a[238:239], v31 offset:12288
    v_mfma_f32_16x16x32_bf16 v[36:39], a[232:235], v[188:191], v[36:39]
    ds_read_b64_tr_b16 a[240:241], v0 offset:8192
    ds_read_b64_tr_b16 a[242:243], v0 offset:12288
    v_exp_f32 v32, v32
    v_exp_f32 v33, v33
    v_exp_f32 v34, v34
    v_exp_f32 v35, v35
    v_or3_b32 v236, v228, v16, s79
    v_cvt_pk_bf16_f32 v40, v32, v33
    v_cvt_pk_bf16_f32 v41, v34, v35
    v_or3_b32 v237, v229, v17, s79
    v_and_b32 v40, v40, v224
    v_and_b32 v41, v41, v225
    v_exp_f32 v36, v36
    v_exp_f32 v37, v37
    v_exp_f32 v38, v38
    v_exp_f32 v39, v39
    v_or3_b32 v238, v230, v16, s79
    v_cvt_pk_bf16_f32 v42, v36, v37
    v_cvt_pk_bf16_f32 v43, v38, v39
    v_or3_b32 v239, v231, v17, s79
    v_and_b32 v42, v42, v226
    v_and_b32 v43, v43, v227
    s_waitcnt lgkmcnt(0)
    s_nop 0
    v_mfma_f32_16x16x32_bf16 a[4:7], a[160:163], v[40:43], a[4:7]
    buffer_load_dwordx4 v[224:227], v20, s[48:51], s80 offen sc1
    v_mfma_f32_16x16x32_bf16 a[20:23], a[164:167], v[40:43], a[20:23]
    v_or3_b32 v240, v232, v16, s79
    v_or3_b32 v241, v233, v17, s79
    v_mfma_f32_16x16x32_bf16 a[36:39], a[168:171], v[40:43], a[36:39]
    v_or3_b32 v242, v234, v16, s79
    v_or3_b32 v243, v235, v17, s79
    v_mfma_f32_16x16x32_bf16 a[52:55], a[172:175], v[40:43], a[52:55]
    v_mfma_f32_16x16x32_bf16 a[68:71], a[176:179], v[40:43], a[68:71]
    buffer_load_dwordx4 v[228:231], v19, s[48:51], s81 offen offset:128 sc1
    v_mfma_f32_16x16x32_bf16 a[84:87], a[180:183], v[40:43], a[84:87]
    buffer_load_dwordx4 v[232:235], v19, s[48:51], s81 offen offset:144 sc1
    v_mfma_f32_16x16x32_bf16 a[100:103], a[236:239], v[40:43], a[100:103]
    v_mfma_f32_16x16x32_bf16 a[116:119], a[240:243], v[40:43], a[116:119]
    v_mfma_f32_16x16x32_bf16 a[188:191], a[248:251], v[40:43], a[188:191]
    s_cmp_lg_u32 s23, 0
    s_cbranch_scc1 L_drnext_standalone__tree_speculative_verify_tree_attention_over_candidate_token_tree__prompt_kernel
    s_cmp_lt_u32 s97, 4
    s_cbranch_scc1 L_loopB_standalone__tree_speculative_verify_tree_attention_over_candidate_token_tree__prompt_kernel
    s_branch L_loop_standalone__tree_speculative_verify_tree_attention_over_candidate_token_tree__prompt_kernel
L_sub2_standalone__tree_speculative_verify_tree_attention_over_candidate_token_tree__prompt_kernel:
    s_waitcnt lgkmcnt(0)
    v_mfma_f32_16x16x32_bf16 v[32:35], a[204:207], v[192:195], 0
    s_mov_b32 s82, s83
    s_mov_b32 s80, s81
    s_ff1_i32_b32 s83, s76
    ds_read_b64_tr_b16 a[160:161], v25 offset:8192
    ds_read_b64_tr_b16 a[162:163], v25 offset:12288
    v_mfma_f32_16x16x32_bf16 v[32:35], a[208:211], v[196:199], v[32:35]
    s_min_u32 s83, s83, 32
    s_add_u32 s62, s76, -1
    s_and_b32 s76, s76, s62
    ds_read_b64_tr_b16 a[164:165], v26 offset:8192
    ds_read_b64_tr_b16 a[166:167], v26 offset:12288
    v_mfma_f32_16x16x32_bf16 v[32:35], a[212:215], v[200:203], v[32:35]
    s_and_b32 s60, s83, 3
    s_lshl_b32 s60, s60, 17
    s_lshr_b32 s61, s83, 2
    ds_read_b64_tr_b16 a[168:169], v27 offset:8192
    ds_read_b64_tr_b16 a[170:171], v27 offset:12288
    v_mfma_f32_16x16x32_bf16 v[32:35], a[216:219], v[204:207], v[32:35]
    s_and_b32 s61, s61, 7
    s_lshl_b32 s61, s61, 11
    s_add_u32 s81, s60, s61
    ds_read_b64_tr_b16 a[172:173], v28 offset:8192
    ds_read_b64_tr_b16 a[174:175], v28 offset:12288
    v_mfma_f32_16x16x32_bf16 v[36:39], a[220:223], v[192:195], 0
    s_add_u32 s81, s81, s77
    s_and_b32 s97, s82, 3
    s_add_u32 s62, s57, 2
    ds_read_b64_tr_b16 a[176:177], v29 offset:8192
    ds_read_b64_tr_b16 a[178:179], v29 offset:12288
    v_mfma_f32_16x16x32_bf16 v[36:39], a[224:227], v[196:199], v[36:39]
    s_cmp_lt_u32 s82, 32
    s_cselect_b32 s79, 0, 0x80000000
    s_cselect_b32 s97, s97, 4
    ds_read_b64_tr_b16 a[180:181], v30 offset:8192
    ds_read_b64_tr_b16 a[182:183], v30 offset:12288
    v_mfma_f32_16x16x32_bf16 v[36:39], a[228:231], v[200:203], v[36:39]
    s_cselect_b32 s62, s62, 31
    s_bitset1_b32 s94, s62
    ds_read_b64_tr_b16 a[236:237], v31 offset:8192
    ds_read_b64_tr_b16 a[238:239], v31 offset:12288
    v_mfma_f32_16x16x32_bf16 v[36:39], a[232:235], v[204:207], v[36:39]
    ds_read_b64_tr_b16 a[240:241], v0 offset:8192
    ds_read_b64_tr_b16 a[242:243], v0 offset:12288
    v_exp_f32 v32, v32
    v_exp_f32 v33, v33
    v_exp_f32 v34, v34
    v_exp_f32 v35, v35
    v_or3_b32 v236, v228, v16, s79
    v_cvt_pk_bf16_f32 v40, v32, v33
    v_cvt_pk_bf16_f32 v41, v34, v35
    v_or3_b32 v237, v229, v17, s79
    v_and_b32 v40, v40, v224
    v_and_b32 v41, v41, v225
    v_exp_f32 v36, v36
    v_exp_f32 v37, v37
    v_exp_f32 v38, v38
    v_exp_f32 v39, v39
    v_or3_b32 v238, v230, v16, s79
    v_cvt_pk_bf16_f32 v42, v36, v37
    v_cvt_pk_bf16_f32 v43, v38, v39
    v_or3_b32 v239, v231, v17, s79
    v_and_b32 v42, v42, v226
    v_and_b32 v43, v43, v227
    s_waitcnt lgkmcnt(0)
    s_nop 0
    v_mfma_f32_16x16x32_bf16 a[8:11], a[160:163], v[40:43], a[8:11]
    buffer_load_dwordx4 v[224:227], v20, s[48:51], s80 offen sc1
    v_mfma_f32_16x16x32_bf16 a[24:27], a[164:167], v[40:43], a[24:27]
    v_or3_b32 v240, v232, v16, s79
    v_or3_b32 v241, v233, v17, s79
    v_mfma_f32_16x16x32_bf16 a[40:43], a[168:171], v[40:43], a[40:43]
    v_or3_b32 v242, v234, v16, s79
    v_or3_b32 v243, v235, v17, s79
    v_mfma_f32_16x16x32_bf16 a[56:59], a[172:175], v[40:43], a[56:59]
    v_mfma_f32_16x16x32_bf16 a[72:75], a[176:179], v[40:43], a[72:75]
    buffer_load_dwordx4 v[228:231], v19, s[48:51], s81 offen offset:128 sc1
    v_mfma_f32_16x16x32_bf16 a[88:91], a[180:183], v[40:43], a[88:91]
    buffer_load_dwordx4 v[232:235], v19, s[48:51], s81 offen offset:144 sc1
    v_mfma_f32_16x16x32_bf16 a[104:107], a[236:239], v[40:43], a[104:107]
    v_mfma_f32_16x16x32_bf16 a[120:123], a[240:243], v[40:43], a[120:123]
    v_mfma_f32_16x16x32_bf16 a[192:195], a[248:251], v[40:43], a[192:195]
    s_cmp_lg_u32 s23, 0
    s_cbranch_scc1 L_drnext_standalone__tree_speculative_verify_tree_attention_over_candidate_token_tree__prompt_kernel
    s_cmp_lt_u32 s97, 4
    s_cbranch_scc1 L_loopB_standalone__tree_speculative_verify_tree_attention_over_candidate_token_tree__prompt_kernel
    s_branch L_loop_standalone__tree_speculative_verify_tree_attention_over_candidate_token_tree__prompt_kernel
L_evt0_standalone__tree_speculative_verify_tree_attention_over_candidate_token_tree__prompt_kernel:
    s_cmp_eq_u32 s57, 30
    s_cbranch_scc1 L_drain_standalone__tree_speculative_verify_tree_attention_over_candidate_token_tree__prompt_kernel
    s_cmp_eq_u32 s57, 2
    s_cbranch_scc1 L_pub_standalone__tree_speculative_verify_tree_attention_over_candidate_token_tree__prompt_kernel
    s_cmp_eq_u32 s57, 6
    s_cbranch_scc1 L_stB_standalone__tree_speculative_verify_tree_attention_over_candidate_token_tree__prompt_kernel
    s_mov_b32 s60, 81920
    s_mov_b32 m0, 160768
    s_nop 0
    buffer_load_dwordx4 v249, s[24:27], s60 offen  lds
    s_mov_b32 s60, 49152
    s_mov_b32 m0, 160768
    s_nop 0
    buffer_load_dwordx4 v249, s[28:31], s60 offen  lds
    s_mov_b32 s60, 81920
    s_mov_b32 m0, 160768
    s_nop 0
    buffer_load_dwordx4 v249, s[28:31], s60 offen  lds
    s_call_b64 s[16:17], L_p1sub_standalone__tree_speculative_verify_tree_attention_over_candidate_token_tree__prompt_kernel
    s_branch L_spec0r_standalone__tree_speculative_verify_tree_attention_over_candidate_token_tree__prompt_kernel
L_p1sub_standalone__tree_speculative_verify_tree_attention_over_candidate_token_tree__prompt_kernel:
    s_mov_b32 s60, 0x3f803f80
    s_mov_b32 s61, 0x00010001
    s_mov_b32 s70, 0x00ff00ff
    v_accvgpr_read_b32 v48, a204
    v_accvgpr_read_b32 v49, a205
    v_accvgpr_read_b32 v50, a206
    v_accvgpr_read_b32 v51, a207
    v_xor_b32 v48, s60, v48
    v_xor_b32 v49, s60, v49
    v_xor_b32 v50, s60, v50
    v_xor_b32 v51, s60, v51
    v_pk_min_u16 v32, v48, s61
    v_pk_min_u16 v33, v49, s61
    v_pk_min_u16 v34, v50, s61
    v_pk_min_u16 v35, v51, s61
    v_accvgpr_read_b32 v52, a208
    v_accvgpr_read_b32 v53, a209
    v_accvgpr_read_b32 v54, a210
    v_accvgpr_read_b32 v55, a211
    v_xor_b32 v52, s60, v52
    v_xor_b32 v53, s60, v53
    v_xor_b32 v54, s60, v54
    v_xor_b32 v55, s60, v55
    v_pk_min_u16 v52, v52, s61
    v_pk_min_u16 v53, v53, s61
    v_pk_min_u16 v54, v54, s61
    v_pk_min_u16 v55, v55, s61
    v_lshl_or_b32 v32, v52, 1, v32
    v_lshl_or_b32 v33, v53, 1, v33
    v_lshl_or_b32 v34, v54, 1, v34
    v_lshl_or_b32 v35, v55, 1, v35
    v_accvgpr_read_b32 v56, a212
    v_accvgpr_read_b32 v57, a213
    v_accvgpr_read_b32 v58, a214
    v_accvgpr_read_b32 v59, a215
    v_xor_b32 v56, s60, v56
    v_xor_b32 v57, s60, v57
    v_xor_b32 v58, s60, v58
    v_xor_b32 v59, s60, v59
    v_pk_min_u16 v56, v56, s61
    v_pk_min_u16 v57, v57, s61
    v_pk_min_u16 v58, v58, s61
    v_pk_min_u16 v59, v59, s61
    v_lshl_or_b32 v32, v56, 2, v32
    v_lshl_or_b32 v33, v57, 2, v33
    v_lshl_or_b32 v34, v58, 2, v34
    v_lshl_or_b32 v35, v59, 2, v35
    v_accvgpr_read_b32 v60, a216
    v_accvgpr_read_b32 v61, a217
    v_accvgpr_read_b32 v62, a218
    v_accvgpr_read_b32 v63, a219
    v_xor_b32 v60, s60, v60
    v_xor_b32 v61, s60, v61
    v_xor_b32 v62, s60, v62
    v_xor_b32 v63, s60, v63
    v_pk_min_u16 v60, v60, s61
    v_pk_min_u16 v61, v61, s61
    v_pk_min_u16 v62, v62, s61
    v_pk_min_u16 v63, v63, s61
    v_lshl_or_b32 v32, v60, 3, v32
    v_lshl_or_b32 v33, v61, 3, v33
    v_lshl_or_b32 v34, v62, 3, v34
    v_lshl_or_b32 v35, v63, 3, v35
    v_accvgpr_read_b32 v48, a220
    v_accvgpr_read_b32 v49, a221
    v_accvgpr_read_b32 v50, a222
    v_accvgpr_read_b32 v51, a223
    v_xor_b32 v48, s60, v48
    v_xor_b32 v49, s60, v49
    v_xor_b32 v50, s60, v50
    v_xor_b32 v51, s60, v51
    v_pk_min_u16 v48, v48, s61
    v_pk_min_u16 v49, v49, s61
    v_pk_min_u16 v50, v50, s61
    v_pk_min_u16 v51, v51, s61
    v_lshl_or_b32 v32, v48, 4, v32
    v_lshl_or_b32 v33, v49, 4, v33
    v_lshl_or_b32 v34, v50, 4, v34
    v_lshl_or_b32 v35, v51, 4, v35
    v_accvgpr_read_b32 v52, a224
    v_accvgpr_read_b32 v53, a225
    v_accvgpr_read_b32 v54, a226
    v_accvgpr_read_b32 v55, a227
    v_xor_b32 v52, s60, v52
    v_xor_b32 v53, s60, v53
    v_xor_b32 v54, s60, v54
    v_xor_b32 v55, s60, v55
    v_pk_min_u16 v52, v52, s61
    v_pk_min_u16 v53, v53, s61
    v_pk_min_u16 v54, v54, s61
    v_pk_min_u16 v55, v55, s61
    v_lshl_or_b32 v32, v52, 5, v32
    v_lshl_or_b32 v33, v53, 5, v33
    v_lshl_or_b32 v34, v54, 5, v34
    v_lshl_or_b32 v35, v55, 5, v35
    v_accvgpr_read_b32 v56, a228
    v_accvgpr_read_b32 v57, a229
    v_accvgpr_read_b32 v58, a230
    v_accvgpr_read_b32 v59, a231
    v_xor_b32 v56, s60, v56
    v_xor_b32 v57, s60, v57
    v_xor_b32 v58, s60, v58
    v_xor_b32 v59, s60, v59
    v_pk_min_u16 v56, v56, s61
    v_pk_min_u16 v57, v57, s61
    v_pk_min_u16 v58, v58, s61
    v_pk_min_u16 v59, v59, s61
    v_lshl_or_b32 v32, v56, 6, v32
    v_lshl_or_b32 v33, v57, 6, v33
    v_lshl_or_b32 v34, v58, 6, v34
    v_lshl_or_b32 v35, v59, 6, v35
    v_accvgpr_read_b32 v60, a232
    v_accvgpr_read_b32 v61, a233
    v_accvgpr_read_b32 v62, a234
    v_accvgpr_read_b32 v63, a235
    v_xor_b32 v60, s60, v60
    v_xor_b32 v61, s60, v61
    v_xor_b32 v62, s60, v62
    v_xor_b32 v63, s60, v63
    v_pk_min_u16 v60, v60, s61
    v_pk_min_u16 v61, v61, s61
    v_pk_min_u16 v62, v62, s61
    v_pk_min_u16 v63, v63, s61
    v_lshl_or_b32 v32, v60, 7, v32
    v_lshl_or_b32 v33, v61, 7, v33
    v_lshl_or_b32 v34, v62, 7, v34
    v_lshl_or_b32 v35, v63, 7, v35
    v_not_b32 v32, v32
    v_and_b32 v32, s70, v32
    v_not_b32 v33, v33
    v_and_b32 v33, s70, v33
    v_not_b32 v34, v34
    v_and_b32 v34, s70, v34
    v_not_b32 v35, v35
    v_and_b32 v35, s70, v35
    v_pk_min_u16 v36, v32, s61
    v_pk_min_u16 v37, v33, s61
    v_add_u32 v36, v36, v37
    v_pk_min_u16 v37, v34, s61
    v_pk_min_u16 v38, v35, s61
    v_add3_u32 v36, v36, v37, v38
    v_lshrrev_b32 v37, 16, v36
    v_and_b32 v36, 0xffff, v36
    v_add_u32 v38, v36, v37
    v_mov_b32 v39, v38
    v_and_b32 v40, 15, v1
    v_lshrrev_b32 v41, 4, v1
    v_add_u32_dpp v39, v39, v39 row_shr:1 row_mask:0xf bank_mask:0xf
    v_lshlrev_b32 v42, 4, v41
    v_add_u32 v42, 151552, v42
    v_add_u32_dpp v39, v39, v39 row_shr:2 row_mask:0xf bank_mask:0xf
    v_lshlrev_b32 v43, 2, v1
    v_add_u32 v43, 151552, v43
    v_add_u32_dpp v39, v39, v39 row_shr:4 row_mask:0xf bank_mask:0xf
    v_and_b32 v46, 7, v40
    v_add_u32 v46, 16, v46
    v_add_u32_dpp v39, v39, v39 row_shr:8 row_mask:0xf bank_mask:0xf
    v_lshlrev_b32 v47, 3, v1
    v_mov_b32 v72, 160768
    v_add_u32_dpp v39, v39, v39 row_bcast:15 row_mask:0xa bank_mask:0xf
    s_nop 0
    s_nop 0
    v_add_u32_dpp v39, v39, v39 row_bcast:31 row_mask:0xc bank_mask:0xf
    s_lshl_b32 s65, s54, 9
    s_lshl_b32 s70, s54, 2
    s_add_u32 s70, s70, 147456
    v_add_u32 v47, s65, v47
    v_readlane_b32 s64, v39, 63
    v_sub_u32 v39, v39, v38
    v_mov_b32 v36, s70
    v_mov_b32 v37, s64
    ds_write_b32 v36, v37
    v_mov_b32 v36, 147456
    v_and_b32 v44, 3, v1
    v_lshlrev_b32 v44, 5, v44
    v_bfe_u32 v37, v1, 2, 3
    v_lshl_add_u32 v44, v37, 2, v44
    v_add_u32 v44, 128, v44
    v_lshlrev_b32 v45, 4, v1
    v_add_u32 v45, 1024, v45
    v_mov_b32 v73, 151552
    s_waitcnt lgkmcnt(0)
    s_barrier
    ds_read_b128 v[48:51], v36
    s_mov_b32 s89, 0xffff0000
    s_mov_b32 s88, 0x07060100
    s_mov_b64 s[62:63], exec
    s_waitcnt lgkmcnt(0)
    v_readfirstlane_b32 s72, v48
    v_readfirstlane_b32 s73, v49
    v_readfirstlane_b32 s74, v50
    v_readfirstlane_b32 s75, v51
    s_mov_b32 s65, 0
    s_cmp_gt_u32 s54, 0
    s_cselect_b32 s70, s72, 0
    s_add_u32 s65, s65, s70
    s_cmp_gt_u32 s54, 1
    s_cselect_b32 s70, s73, 0
    s_add_u32 s65, s65, s70
    s_cmp_gt_u32 s54, 2
    s_cselect_b32 s70, s74, 0
    s_add_u32 s65, s65, s70
    s_add_u32 s64, s72, s73
    s_add_u32 s64, s64, s74
    s_add_u32 s64, s64, s75
    v_add_u32 v39, s65, v39
    s_mov_b32 s70, 0xffff
    v_add_u32 v56, 0, v47
    v_lshl_or_b32 v56, v32, 16, v56
    v_add_u32 v57, 1, v47
    v_and_or_b32 v57, v32, s89, v57
    v_add_u32 v58, 2, v47
    v_lshl_or_b32 v58, v33, 16, v58
    v_add_u32 v59, 3, v47
    v_and_or_b32 v59, v33, s89, v59
    v_cmp_lt_u32 s[4:5], s70, v56
    v_cmp_lt_u32 s[6:7], s70, v57
    v_cmp_lt_u32 s[8:9], s70, v58
    v_cmp_lt_u32 s[10:11], s70, v59
    v_lshl_add_u32 v74, v39, 2, v73
    v_addc_co_u32 v39, s[66:67], 0, v39, s[4:5]
    v_cndmask_b32 v74, v72, v74, s[4:5]
    ds_write_b32 v74, v56
    v_lshl_add_u32 v75, v39, 2, v73
    v_addc_co_u32 v39, s[66:67], 0, v39, s[6:7]
    v_cndmask_b32 v75, v72, v75, s[6:7]
    ds_write_b32 v75, v57
    v_lshl_add_u32 v74, v39, 2, v73
    v_addc_co_u32 v39, s[66:67], 0, v39, s[8:9]
    v_cndmask_b32 v74, v72, v74, s[8:9]
    ds_write_b32 v74, v58
    v_lshl_add_u32 v75, v39, 2, v73
    v_addc_co_u32 v39, s[66:67], 0, v39, s[10:11]
    v_cndmask_b32 v75, v72, v75, s[10:11]
    ds_write_b32 v75, v59
    v_add_u32 v56, 4, v47
    v_lshl_or_b32 v56, v34, 16, v56
    v_add_u32 v57, 5, v47
    v_and_or_b32 v57, v34, s89, v57
    v_add_u32 v58, 6, v47
    v_lshl_or_b32 v58, v35, 16, v58
    v_add_u32 v59, 7, v47
    v_and_or_b32 v59, v35, s89, v59
    v_cmp_lt_u32 s[4:5], s70, v56
    v_cmp_lt_u32 s[6:7], s70, v57
    v_cmp_lt_u32 s[8:9], s70, v58
    v_cmp_lt_u32 s[10:11], s70, v59
    v_lshl_add_u32 v74, v39, 2, v73
    v_addc_co_u32 v39, s[66:67], 0, v39, s[4:5]
    v_cndmask_b32 v74, v72, v74, s[4:5]
    ds_write_b32 v74, v56
    v_lshl_add_u32 v75, v39, 2, v73
    v_addc_co_u32 v39, s[66:67], 0, v39, s[6:7]
    v_cndmask_b32 v75, v72, v75, s[6:7]
    ds_write_b32 v75, v57
    v_lshl_add_u32 v74, v39, 2, v73
    v_addc_co_u32 v39, s[66:67], 0, v39, s[8:9]
    v_cndmask_b32 v74, v72, v74, s[8:9]
    ds_write_b32 v74, v58
    v_lshl_add_u32 v75, v39, 2, v73
    v_addc_co_u32 v39, s[66:67], 0, v39, s[10:11]
    v_cndmask_b32 v75, v72, v75, s[10:11]
    ds_write_b32 v75, v59
    s_lshl_b32 s70, s64, 2
    s_add_u32 s70, s70, 151552
    v_lshl_add_u32 v74, v1, 2, s70
    v_mov_b32 v75, 0xfff
    ds_write_b32 v74, v75
    s_add_u32 s71, s64, 31
    s_lshr_b32 s71, s71, 5
    s_lshr_b32 s70, s2, 4
    s_lshl_b32 s70, s70, 7
    s_and_b32 s65, s2, 15
    s_lshl_b32 s65, s65, 2
    s_add_u32 s70, s70, s65
    s_add_u32 s70, s70, 67108864
    v_mov_b32 v76, s71
    s_mov_b64 exec, 1
    buffer_atomic_swap v76, off, s[48:51], s70
    s_mov_b64 exec, s[62:63]
    s_mov_b32 s72, s54
    s_lshl_b32 s73, s2, 17
    s_waitcnt lgkmcnt(0)
    s_barrier
L_p1step_standalone__tree_speculative_verify_tree_attention_over_candidate_token_tree__prompt_kernel:
    s_cmp_ge_u32 s72, s71
    s_cbranch_scc1 L_p1done_standalone__tree_speculative_verify_tree_attention_over_candidate_token_tree__prompt_kernel
    s_lshl_b32 s74, s72, 7
    s_lshl_b32 s75, s72, 11
    s_add_u32 s75, s75, s73
    v_add_u32 v74, s74, v42
    v_add_u32 v75, s74, v43
    ds_read_b32 v76, v75
    ds_read_b128 v[48:51], v74
    ds_read_b128 v[52:55], v74 offset:64
    v_mov_b32 v75, 0x80000000
    s_waitcnt lgkmcnt(2)
    v_and_b32 v36, 0xfff, v76
    v_cmp_eq_u32 vcc, 0xfff, v36
    v_lshlrev_b32 v36, 8, v36
    s_nop 0
    v_cndmask_b32 v36, v36, v75, vcc
    s_mov_b32 exec_lo, -1
    s_mov_b32 exec_hi, 0
    buffer_atomic_swap v36, v44, s[48:51], s75 offen
    s_mov_b64 exec, s[62:63]
    s_waitcnt lgkmcnt(0)
    v_bfe_i32 v56, v48, v46, 1
    v_bfe_i32 v57, v49, v46, 1
    v_bfe_i32 v58, v50, v46, 1
    v_bfe_i32 v59, v51, v46, 1
    v_bfe_i32 v60, v52, v46, 1
    v_bfe_i32 v61, v53, v46, 1
    v_bfe_i32 v62, v54, v46, 1
    v_bfe_i32 v63, v55, v46, 1
    v_perm_b32 v64, v57, v56, s88
    v_perm_b32 v65, v59, v58, s88
    v_perm_b32 v66, v61, v60, s88
    v_perm_b32 v67, v63, v62, s88
    buffer_atomic_swap_x2 v[64:65], v45, s[48:51], s75 offen
    buffer_atomic_swap_x2 v[66:67], v45, s[48:51], s75 offen offset:8
    s_add_u32 s72, s72, 4
    s_branch L_p1step_standalone__tree_speculative_verify_tree_attention_over_candidate_token_tree__prompt_kernel
L_p1done_standalone__tree_speculative_verify_tree_attention_over_candidate_token_tree__prompt_kernel:
    s_setpc_b64 s[16:17]
L_pub_standalone__tree_speculative_verify_tree_attention_over_candidate_token_tree__prompt_kernel:
    s_cmp_lg_u32 s54, 3
    s_cbranch_scc1 L_spec0r_standalone__tree_speculative_verify_tree_attention_over_candidate_token_tree__prompt_kernel
    s_mov_b32 s64, s18
    s_and_b32 s65, s19, 0xffff
    s_mov_b32 s66, 0x100
    s_mov_b32 s67, 0x20000
    s_and_b32 s60, s53, 3
    s_lshl_b32 s60, s60, 6
    s_lshr_b32 s61, s53, 2
    s_lshl_b32 s61, s61, 2
    s_add_u32 s60, s60, s61
    v_mov_b32 v247, 1
    s_mov_b64 s[62:63], exec
    s_mov_b64 exec, 1
    buffer_atomic_add v247, off, s[64:67], s60
    s_mov_b64 exec, s[62:63]
    s_branch L_spec0r_standalone__tree_speculative_verify_tree_attention_over_candidate_token_tree__prompt_kernel
L_stB_standalone__tree_speculative_verify_tree_attention_over_candidate_token_tree__prompt_kernel:
    s_cmp_lg_u32 s54, 3
    s_cbranch_scc1 L_verd_standalone__tree_speculative_verify_tree_attention_over_candidate_token_tree__prompt_kernel
    v_readfirstlane_b32 s61, v247
    s_mov_b32 s89, 1
    s_cmp_ge_u32 s61, 16
    s_cbranch_scc1 L_stBok_standalone__tree_speculative_verify_tree_attention_over_candidate_token_tree__prompt_kernel
    s_mov_b32 s64, s18
    s_and_b32 s65, s19, 0xffff
    s_mov_b32 s66, 0x100
    s_mov_b32 s67, 0x20000
    s_and_b32 s60, s53, 3
    s_lshl_b32 s60, s60, 6
    s_lshr_b32 s61, s53, 2
    s_lshl_b32 s61, s61, 2
    s_add_u32 s60, s60, s61
    s_mov_b32 s63, 0
L_poll_standalone__tree_speculative_verify_tree_attention_over_candidate_token_tree__prompt_kernel:
    buffer_load_dword v247, off, s[64:67], s60 sc1
    s_waitcnt vmcnt(0)
    v_readfirstlane_b32 s61, v247
    s_nop 0
    s_cmp_ge_u32 s61, 16
    s_cbranch_scc1 L_stBok_standalone__tree_speculative_verify_tree_attention_over_candidate_token_tree__prompt_kernel
    s_add_u32 s63, s63, 1
    s_cmp_lt_u32 s63, 20000
    s_cbranch_scc1 L_poll_standalone__tree_speculative_verify_tree_attention_over_candidate_token_tree__prompt_kernel
    s_mov_b32 s89, 2
L_stBok_standalone__tree_speculative_verify_tree_attention_over_candidate_token_tree__prompt_kernel:
    v_mov_b32 v247, 160320
    v_mov_b32 v32, s89
    ds_write_b32 v247, v32
L_verd_standalone__tree_speculative_verify_tree_attention_over_candidate_token_tree__prompt_kernel:
    v_mov_b32 v33, 160320
L_vspin_standalone__tree_speculative_verify_tree_attention_over_candidate_token_tree__prompt_kernel:
    ds_read_b32 v247, v33
    s_waitcnt lgkmcnt(0)
    v_readfirstlane_b32 s61, v247
    s_nop 0
    s_cmp_eq_u32 s61, 0
    s_cbranch_scc1 L_vspin_standalone__tree_speculative_verify_tree_attention_over_candidate_token_tree__prompt_kernel
    s_cmp_eq_u32 s61, 1
    s_cselect_b32 s96, 0, 1
    s_cbranch_scc0 L_spec0r_standalone__tree_speculative_verify_tree_attention_over_candidate_token_tree__prompt_kernel
    s_lshl_b32 s60, s53, 7
    s_lshl_b32 s61, s54, 4
    s_add_u32 s60, s60, s61
    s_add_u32 s60, s60, 0x4000000
    buffer_load_dwordx4 v[224:227], off, s[48:51], s60 sc1
    s_mov_b32 s81, s77
    buffer_load_dwordx4 v[228:231], v19, s[48:51], s81 offen offset:128 sc1
    buffer_load_dwordx4 v[232:235], v19, s[48:51], s81 offen offset:144 sc1
    s_branch L_spec0r_standalone__tree_speculative_verify_tree_attention_over_candidate_token_tree__prompt_kernel
L_spina_standalone__tree_speculative_verify_tree_attention_over_candidate_token_tree__prompt_kernel:
    ds_read_b32 v252, v253
    s_waitcnt lgkmcnt(0)
    v_cmp_gt_u32 vcc, v248, v252
    s_nop 0
    s_cbranch_vccnz L_spina_standalone__tree_speculative_verify_tree_attention_over_candidate_token_tree__prompt_kernel
    s_branch L_spinra_standalone__tree_speculative_verify_tree_attention_over_candidate_token_tree__prompt_kernel
L_spinb_standalone__tree_speculative_verify_tree_attention_over_candidate_token_tree__prompt_kernel:
    ds_read_b32 v252, v253
    s_waitcnt lgkmcnt(0)
    v_cmp_gt_u32 vcc, v248, v252
    s_nop 0
    s_cbranch_vccnz L_spinb_standalone__tree_speculative_verify_tree_attention_over_candidate_token_tree__prompt_kernel
    s_branch L_spinrb_standalone__tree_speculative_verify_tree_attention_over_candidate_token_tree__prompt_kernel
L_spint_standalone__tree_speculative_verify_tree_attention_over_candidate_token_tree__prompt_kernel:
    ds_read_b32 v252, v253
    s_waitcnt lgkmcnt(0)
    v_cmp_gt_u32 vcc, v248, v252
    s_nop 0
    s_cbranch_vccnz L_spint_standalone__tree_speculative_verify_tree_attention_over_candidate_token_tree__prompt_kernel
    s_branch L_spinrt_standalone__tree_speculative_verify_tree_attention_over_candidate_token_tree__prompt_kernel
L_spinc_standalone__tree_speculative_verify_tree_attention_over_candidate_token_tree__prompt_kernel:
    ds_read_b32 v252, v253
    s_waitcnt lgkmcnt(0)
    v_cmp_gt_u32 vcc, v248, v252
    s_nop 0
    s_cbranch_vccnz L_spinc_standalone__tree_speculative_verify_tree_attention_over_candidate_token_tree__prompt_kernel
    s_branch L_spinrc_standalone__tree_speculative_verify_tree_attention_over_candidate_token_tree__prompt_kernel
L_spind_standalone__tree_speculative_verify_tree_attention_over_candidate_token_tree__prompt_kernel:
    ds_read_b32 v252, v253
    s_waitcnt lgkmcnt(0)
    v_cmp_gt_u32 vcc, v248, v252
    s_nop 0
    s_cbranch_vccnz L_spind_standalone__tree_speculative_verify_tree_attention_over_candidate_token_tree__prompt_kernel
    s_branch L_spinrd_standalone__tree_speculative_verify_tree_attention_over_candidate_token_tree__prompt_kernel
L_w0b_standalone__tree_speculative_verify_tree_attention_over_candidate_token_tree__prompt_kernel:
    s_waitcnt vmcnt(0)
    s_branch L_w0rb_standalone__tree_speculative_verify_tree_attention_over_candidate_token_tree__prompt_kernel
L_drnext_standalone__tree_speculative_verify_tree_attention_over_candidate_token_tree__prompt_kernel:
    s_waitcnt vmcnt(0)
L_drain_standalone__tree_speculative_verify_tree_attention_over_candidate_token_tree__prompt_kernel:
    s_cmp_ge_u32 s97, 4
    s_cbranch_scc1 L_tail_standalone__tree_speculative_verify_tree_attention_over_candidate_token_tree__prompt_kernel
    s_add_u32 m0, s78, 0
    s_nop 0
    buffer_load_dwordx4 v236, s[40:43], 0 offen lds
    s_add_u32 m0, s78, 1024
    s_nop 0
    buffer_load_dwordx4 v237, s[40:43], 0 offen lds
    s_add_u32 m0, s78, 2048
    s_nop 0
    buffer_load_dwordx4 v238, s[40:43], 0 offen lds
    s_add_u32 m0, s78, 3072
    s_nop 0
    buffer_load_dwordx4 v239, s[40:43], 0 offen lds
    s_add_u32 m0, s78, 4096
    s_nop 0
    buffer_load_dwordx4 v240, s[40:43], 0 offen lds
    s_add_u32 m0, s78, 5120
    s_nop 0
    buffer_load_dwordx4 v241, s[40:43], 0 offen lds
    s_add_u32 m0, s78, 6144
    s_nop 0
    buffer_load_dwordx4 v242, s[40:43], 0 offen lds
    s_add_u32 m0, s78, 7168
    s_nop 0
    buffer_load_dwordx4 v243, s[40:43], 0 offen lds
    s_add_u32 m0, s78, 8192
    s_nop 0
    buffer_load_dwordx4 v236, s[44:47], 0 offen lds
    s_add_u32 m0, s78, 9216
    s_nop 0
    buffer_load_dwordx4 v237, s[44:47], 0 offen lds
    s_add_u32 m0, s78, 10240
    s_nop 0
    buffer_load_dwordx4 v238, s[44:47], 0 offen lds
    s_add_u32 m0, s78, 11264
    s_nop 0
    buffer_load_dwordx4 v239, s[44:47], 0 offen lds
    s_add_u32 m0, s78, 12288
    s_nop 0
    buffer_load_dwordx4 v240, s[44:47], 0 offen lds
    s_add_u32 m0, s78, 13312
    s_nop 0
    buffer_load_dwordx4 v241, s[44:47], 0 offen lds
    s_add_u32 m0, s78, 14336
    s_nop 0
    buffer_load_dwordx4 v242, s[44:47], 0 offen lds
    s_add_u32 m0, s78, 15360
    s_nop 0
    buffer_load_dwordx4 v243, s[44:47], 0 offen lds
    s_waitcnt vmcnt(0)
    ds_read_b128 a[204:207], v21 offset:0
    ds_read_b128 a[208:211], v22 offset:0
    ds_read_b128 a[212:215], v23 offset:0
    ds_read_b128 a[216:219], v24 offset:0
    ds_read_b128 a[220:223], v21 offset:4096
    ds_read_b128 a[224:227], v22 offset:4096
    ds_read_b128 a[228:231], v23 offset:4096
    ds_read_b128 a[232:235], v24 offset:4096
    s_mov_b32 s23, 1
    s_branch L_disp_standalone__tree_speculative_verify_tree_attention_over_candidate_token_tree__prompt_kernel
L_tail_standalone__tree_speculative_verify_tree_attention_over_candidate_token_tree__prompt_kernel:
    s_cmp_lg_u32 s96, 0
    s_cbranch_scc1 L_slow_standalone__tree_speculative_verify_tree_attention_over_candidate_token_tree__prompt_kernel
    ds_read_b32 v252, v253
    v_exp_f32 v93, v93
    v_exp_f32 v94, v94
    v_cvt_pk_bf16_f32 v151, v90, v91
    v_cvt_pk_bf16_f32 v158, v92, v93
    v_exp_f32 v95, v95
    s_nop 0
    v_cvt_pk_bf16_f32 v159, v94, v95
    s_waitcnt lgkmcnt(0)
    v_cmp_gt_u32 vcc, v248, v252
    v_lshrrev_b32 v240, 4, v246
    v_and_b32 v238, 15, v240
    v_lshrrev_b32 v239, 4, v240
    s_cbranch_vccnz L_spint_standalone__tree_speculative_verify_tree_attention_over_candidate_token_tree__prompt_kernel
L_spinrt_standalone__tree_speculative_verify_tree_attention_over_candidate_token_tree__prompt_kernel:
    ds_read_b64_tr_b16 a[128:129], v6 offset:16384
    ds_read_b64_tr_b16 a[130:131], v6 offset:20480
    ds_read_b64_tr_b16 a[132:133], v6 offset:24576
    ds_read_b64_tr_b16 a[134:135], v6 offset:28672
    ds_read_b64_tr_b16 a[136:137], v7 offset:16384
    ds_read_b64_tr_b16 a[138:139], v7 offset:20480
    ds_read_b64_tr_b16 a[140:141], v7 offset:24576
    ds_read_b64_tr_b16 a[142:143], v7 offset:28672
    ds_read_b64_tr_b16 a[144:145], v8 offset:16384
    ds_read_b64_tr_b16 a[146:147], v8 offset:20480
    ds_read_b64_tr_b16 a[148:149], v8 offset:24576
    ds_read_b64_tr_b16 a[150:151], v8 offset:28672
    ds_read_b64_tr_b16 a[152:153], v9 offset:16384
    ds_read_b64_tr_b16 a[154:155], v9 offset:20480
    ds_read_b64_tr_b16 a[156:157], v9 offset:24576
    ds_read_b64_tr_b16 a[158:159], v9 offset:28672
    s_mov_b64 s[70:71], exec
    s_mov_b32 s64, 0x35800000
    s_mov_b32 s65, 0x71800000
    s_waitcnt lgkmcnt(12)
    v_smfmac_f32_16x16x64_bf16 a[184:187], a[200:203], v[128:135], v18
    ds_read_b64_tr_b16 a[160:161], v10 offset:16384
    ds_read_b64_tr_b16 a[162:163], v10 offset:20480
    v_mfma_f32_16x16x32_bf16 a[0:3], a[128:131], v[128:131], a[0:3]
    ds_read_b64_tr_b16 a[164:165], v10 offset:24576
    ds_read_b64_tr_b16 a[166:167], v10 offset:28672
    v_mfma_f32_16x16x32_bf16 a[0:3], a[132:135], v[132:135], a[0:3]
    ds_read_b64_tr_b16 a[168:169], v11 offset:16384
    ds_read_b64_tr_b16 a[170:171], v11 offset:20480
    s_waitcnt lgkmcnt(14)
    v_mfma_f32_16x16x32_bf16 a[16:19], a[136:139], v[128:131], a[16:19]
    ds_read_b64_tr_b16 a[172:173], v11 offset:24576
    ds_read_b64_tr_b16 a[174:175], v11 offset:28672
    v_mfma_f32_16x16x32_bf16 a[16:19], a[140:143], v[132:135], a[16:19]
    ds_read_b64_tr_b16 a[176:177], v12 offset:16384
    ds_read_b64_tr_b16 a[178:179], v12 offset:20480
    s_waitcnt lgkmcnt(14)
    v_mfma_f32_16x16x32_bf16 a[32:35], a[144:147], v[128:131], a[32:35]
    ds_read_b64_tr_b16 a[180:181], v12 offset:24576
    ds_read_b64_tr_b16 a[182:183], v12 offset:28672
    v_mfma_f32_16x16x32_bf16 a[32:35], a[148:151], v[132:135], a[32:35]
    ds_read_b64_tr_b16 a[204:205], v13 offset:16384
    ds_read_b64_tr_b16 a[206:207], v13 offset:20480
    s_waitcnt lgkmcnt(14)
    v_mfma_f32_16x16x32_bf16 a[48:51], a[152:155], v[128:131], a[48:51]
    ds_read_b64_tr_b16 a[208:209], v13 offset:24576
    ds_read_b64_tr_b16 a[210:211], v13 offset:28672
    v_lshrrev_b32 v240, 1, v239
    v_xor_b32 v240, v240, v238
    v_and_b32 v241, 1, v239
    v_mfma_f32_16x16x32_bf16 a[48:51], a[156:159], v[132:135], a[48:51]
    v_lshlrev_b32 v241, 3, v241
    v_lshl_add_u32 v241, v238, 8, v241
    v_add_u32 v241, s78, v241
    s_waitcnt lgkmcnt(12)
    v_mfma_f32_16x16x32_bf16 a[64:67], a[160:163], v[128:131], a[64:67]
    v_xor_b32 v224, 0, v240
    v_lshl_add_u32 v224, v224, 4, v241
    v_xor_b32 v225, 2, v240
    v_mfma_f32_16x16x32_bf16 a[64:67], a[164:167], v[132:135], a[64:67]
    v_lshl_add_u32 v225, v225, 4, v241
    v_xor_b32 v226, 4, v240
    v_lshl_add_u32 v226, v226, 4, v241
    s_waitcnt lgkmcnt(8)
    v_mfma_f32_16x16x32_bf16 a[80:83], a[168:171], v[128:131], a[80:83]
    v_xor_b32 v227, 6, v240
    v_lshl_add_u32 v227, v227, 4, v241
    v_xor_b32 v228, 8, v240
    v_mfma_f32_16x16x32_bf16 a[80:83], a[172:175], v[132:135], a[80:83]
    v_lshl_add_u32 v228, v228, 4, v241
    v_xor_b32 v229, 10, v240
    v_lshl_add_u32 v229, v229, 4, v241
    s_waitcnt lgkmcnt(4)
    v_mfma_f32_16x16x32_bf16 a[96:99], a[176:179], v[128:131], a[96:99]
    v_xor_b32 v230, 12, v240
    v_lshl_add_u32 v230, v230, 4, v241
    v_xor_b32 v231, 14, v240
    v_mfma_f32_16x16x32_bf16 a[96:99], a[180:183], v[132:135], a[96:99]
    v_lshl_add_u32 v231, v231, 4, v241
    v_lshlrev_b32 v241, 8, v239
    v_add_u32 v241, s78, v241
    s_waitcnt lgkmcnt(0)
    v_mfma_f32_16x16x32_bf16 a[112:115], a[204:207], v[128:131], a[112:115]
    v_add_u32 v232, 0, v239
    v_xor_b32 v232, v232, v238
    v_lshl_add_u32 v232, v232, 4, v241
    v_mfma_f32_16x16x32_bf16 a[112:115], a[208:211], v[132:135], a[112:115]
    v_add_u32 v233, 4, v239
    v_xor_b32 v233, v233, v238
    v_lshl_add_u32 v233, v233, 4, v241
    v_add_u32 v234, 8, v239
    v_xor_b32 v234, v234, v238
    v_lshl_add_u32 v234, v234, 4, v241
    v_add_u32 v235, 12, v239
    v_xor_b32 v235, v235, v238
    v_lshl_add_u32 v235, v235, 4, v241
    v_smfmac_f32_16x16x64_bf16 a[188:191], a[200:203], v[136:143], v18
    v_accvgpr_read_b32 v236, a184
    v_accvgpr_read_b32 v237, a185
    v_accvgpr_read_b32 v32, a0
    v_add_f32 v236, v236, v237
    v_accvgpr_read_b32 v33, a1
    v_cmp_lt_f32 vcc, s64, v236
    v_mfma_f32_16x16x32_bf16 a[4:7], a[128:131], v[136:139], a[4:7]
    v_accvgpr_read_b32 v34, a2
    v_accvgpr_read_b32 v35, a3
    s_and_b64 s[70:71], s[70:71], vcc
    v_cmp_gt_f32 vcc, s65, v236
    v_rcp_f32 v236, v236
    v_accvgpr_read_b32 v36, a16
    v_mfma_f32_16x16x32_bf16 a[4:7], a[132:135], v[140:143], a[4:7]
    v_accvgpr_read_b32 v37, a17
    s_and_b64 s[70:71], s[70:71], vcc
    v_accvgpr_read_b32 v38, a18
    v_accvgpr_read_b32 v39, a19
    v_accvgpr_read_b32 v40, a32
    v_accvgpr_read_b32 v41, a33
    v_mfma_f32_16x16x32_bf16 a[20:23], a[136:139], v[136:139], a[20:23]
    v_accvgpr_read_b32 v42, a34
    v_accvgpr_read_b32 v43, a35
    v_mul_f32 v32, v236, v32
    v_mul_f32 v33, v236, v33
    v_mul_f32 v34, v236, v34
    v_mul_f32 v35, v236, v35
    v_mfma_f32_16x16x32_bf16 a[20:23], a[140:143], v[140:143], a[20:23]
    v_cvt_pk_bf16_f32 v96, v32, v33
    v_cvt_pk_bf16_f32 v97, v34, v35
    v_accvgpr_read_b32 v44, a48
    v_accvgpr_read_b32 v45, a49
    v_accvgpr_read_b32 v46, a50
    v_accvgpr_read_b32 v47, a51
    v_mfma_f32_16x16x32_bf16 a[36:39], a[144:147], v[136:139], a[36:39]
    v_mul_f32 v36, v236, v36
    v_mul_f32 v37, v236, v37
    v_mul_f32 v38, v236, v38
    v_mul_f32 v39, v236, v39
    v_cvt_pk_bf16_f32 v98, v36, v37
    v_cvt_pk_bf16_f32 v99, v38, v39
    v_mfma_f32_16x16x32_bf16 a[36:39], a[148:151], v[140:143], a[36:39]
    ds_write_b64 v224, v[96:97] offset:0
    v_accvgpr_read_b32 v48, a64
    v_accvgpr_read_b32 v49, a65
    v_accvgpr_read_b32 v50, a66
    v_accvgpr_read_b32 v51, a67
    v_mul_f32 v40, v236, v40
    v_mfma_f32_16x16x32_bf16 a[52:55], a[152:155], v[136:139], a[52:55]
    v_mul_f32 v41, v236, v41
    v_mul_f32 v42, v236, v42
    v_mul_f32 v43, v236, v43
    v_cvt_pk_bf16_f32 v100, v40, v41
    v_cvt_pk_bf16_f32 v101, v42, v43
    ds_write_b64 v225, v[98:99] offset:0
    v_mfma_f32_16x16x32_bf16 a[52:55], a[156:159], v[140:143], a[52:55]
    v_mfma_f32_16x16x32_bf16 a[244:247], a[248:251], v[96:99], 0
    v_accvgpr_read_b32 v52, a80
    v_accvgpr_read_b32 v53, a81
    v_accvgpr_read_b32 v54, a82
    v_accvgpr_read_b32 v55, a83
    v_mul_f32 v44, v236, v44
    v_mfma_f32_16x16x32_bf16 a[68:71], a[160:163], v[136:139], a[68:71]
    v_mul_f32 v45, v236, v45
    v_mul_f32 v46, v236, v46
    v_mul_f32 v47, v236, v47
    v_cvt_pk_bf16_f32 v102, v44, v45
    v_cvt_pk_bf16_f32 v103, v46, v47
    ds_write_b64 v226, v[100:101] offset:0
    v_mfma_f32_16x16x32_bf16 a[68:71], a[164:167], v[140:143], a[68:71]
    v_accvgpr_read_b32 v56, a96
    v_accvgpr_read_b32 v57, a97
    v_accvgpr_read_b32 v58, a98
    v_accvgpr_read_b32 v59, a99
    v_mul_f32 v48, v236, v48
    v_mul_f32 v49, v236, v49
    v_mfma_f32_16x16x32_bf16 a[84:87], a[168:171], v[136:139], a[84:87]
    v_mul_f32 v50, v236, v50
    v_mul_f32 v51, v236, v51
    v_cvt_pk_bf16_f32 v104, v48, v49
    v_cvt_pk_bf16_f32 v105, v50, v51
    ds_write_b64 v227, v[102:103] offset:0
    v_mfma_f32_16x16x32_bf16 a[244:247], a[248:251], v[100:103], a[244:247]
    v_mfma_f32_16x16x32_bf16 a[84:87], a[172:175], v[140:143], a[84:87]
    v_accvgpr_read_b32 v60, a112
    v_accvgpr_read_b32 v61, a113
    v_accvgpr_read_b32 v62, a114
    v_accvgpr_read_b32 v63, a115
    v_mul_f32 v52, v236, v52
    v_mul_f32 v53, v236, v53
    v_mfma_f32_16x16x32_bf16 a[100:103], a[176:179], v[136:139], a[100:103]
    v_mul_f32 v54, v236, v54
    v_mul_f32 v55, v236, v55
    v_cvt_pk_bf16_f32 v106, v52, v53
    v_cvt_pk_bf16_f32 v107, v54, v55
    ds_write_b64 v228, v[104:105] offset:0
    v_mul_f32 v56, v236, v56
    v_mfma_f32_16x16x32_bf16 a[100:103], a[180:183], v[140:143], a[100:103]
    v_mul_f32 v57, v236, v57
    v_mul_f32 v58, v236, v58
    v_mul_f32 v59, v236, v59
    v_cvt_pk_bf16_f32 v108, v56, v57
    v_cvt_pk_bf16_f32 v109, v58, v59
    ds_write_b64 v229, v[106:107] offset:0
    v_mfma_f32_16x16x32_bf16 a[116:119], a[204:207], v[136:139], a[116:119]
    v_mfma_f32_16x16x32_bf16 a[244:247], a[248:251], v[104:107], a[244:247]
    v_mul_f32 v60, v236, v60
    v_mul_f32 v61, v236, v61
    v_mul_f32 v62, v236, v62
    v_mul_f32 v63, v236, v63
    v_cvt_pk_bf16_f32 v110, v60, v61
    v_mfma_f32_16x16x32_bf16 a[116:119], a[208:211], v[140:143], a[116:119]
    v_cvt_pk_bf16_f32 v111, v62, v63
    ds_write_b64 v230, v[108:109] offset:0
    ds_write_b64 v231, v[110:111] offset:0
    s_nop 0
    v_mfma_f32_16x16x32_bf16 a[244:247], a[248:251], v[108:111], a[244:247]
    v_smfmac_f32_16x16x64_bf16 a[192:195], a[200:203], v[144:151], v18
    v_accvgpr_read_b32 v236, a188
    v_accvgpr_read_b32 v237, a189
    v_accvgpr_read_b32 v64, a4
    v_add_f32 v236, v236, v237
    v_accvgpr_read_b32 v65, a5
    v_cmp_lt_f32 vcc, s64, v236
    v_accvgpr_read_b32 v66, a6
    v_mfma_f32_16x16x32_bf16 a[8:11], a[128:131], v[144:147], a[8:11]
    v_accvgpr_read_b32 v67, a7
    s_and_b64 s[70:71], s[70:71], vcc
    v_cmp_gt_f32 vcc, s65, v236
    v_rcp_f32 v236, v236
    v_accvgpr_read_b32 v68, a20
    v_accvgpr_read_b32 v69, a21
    s_and_b64 s[70:71], s[70:71], vcc
    v_mfma_f32_16x16x32_bf16 a[8:11], a[132:135], v[148:151], a[8:11]
    v_accvgpr_read_b32 v70, a22
    v_accvgpr_read_b32 v71, a23
    v_accvgpr_read_b32 v72, a36
    v_accvgpr_read_b32 v73, a37
    v_accvgpr_read_b32 v74, a38
    v_accvgpr_read_b32 v75, a39
    v_mul_f32 v64, v236, v64
    v_mfma_f32_16x16x32_bf16 a[24:27], a[136:139], v[144:147], a[24:27]
    v_mul_f32 v65, v236, v65
    v_mul_f32 v66, v236, v66
    v_mul_f32 v67, v236, v67
    v_cvt_pk_bf16_f32 v112, v64, v65
    s_waitcnt lgkmcnt(0)
    ds_read_b128 v[32:35], v232 offset:0
    ds_read_b128 v[36:39], v233 offset:1024
    v_mfma_f32_16x16x32_bf16 a[24:27], a[140:143], v[148:151], a[24:27]
    ds_read_b128 v[40:43], v234 offset:2048
    ds_read_b128 v[44:47], v235 offset:3072
    v_cvt_pk_bf16_f32 v113, v66, v67
    v_accvgpr_read_b32 v76, a52
    v_accvgpr_read_b32 v77, a53
    v_accvgpr_read_b32 v78, a54
    v_mfma_f32_16x16x32_bf16 a[40:43], a[144:147], v[144:147], a[40:43]
    v_accvgpr_read_b32 v79, a55
    v_mul_f32 v68, v236, v68
    v_mul_f32 v69, v236, v69
    v_mul_f32 v70, v236, v70
    v_mul_f32 v71, v236, v71
    v_cvt_pk_bf16_f32 v114, v68, v69
    v_cvt_pk_bf16_f32 v115, v70, v71
    v_mfma_f32_16x16x32_bf16 a[40:43], a[148:151], v[148:151], a[40:43]
    ds_write_b64 v224, v[112:113] offset:4096
    v_accvgpr_read_b32 v80, a68
    v_accvgpr_read_b32 v81, a69
    v_accvgpr_read_b32 v82, a70
    v_accvgpr_read_b32 v83, a71
    v_mul_f32 v72, v236, v72
    v_mul_f32 v73, v236, v73
    v_mfma_f32_16x16x32_bf16 a[56:59], a[152:155], v[144:147], a[56:59]
    v_mul_f32 v74, v236, v74
    v_mul_f32 v75, v236, v75
    v_cvt_pk_bf16_f32 v116, v72, v73
    v_cvt_pk_bf16_f32 v117, v74, v75
    ds_write_b64 v225, v[114:115] offset:4096
    v_mfma_f32_16x16x32_bf16 a[244:247], a[248:251], v[112:115], a[244:247]
    v_accvgpr_read_b32 v84, a84
    v_mfma_f32_16x16x32_bf16 a[56:59], a[156:159], v[148:151], a[56:59]
    v_accvgpr_read_b32 v85, a85
    v_accvgpr_read_b32 v86, a86
    v_accvgpr_read_b32 v87, a87
    v_mul_f32 v76, v236, v76
    v_mul_f32 v77, v236, v77
    v_mul_f32 v78, v236, v78
    v_mfma_f32_16x16x32_bf16 a[72:75], a[160:163], v[144:147], a[72:75]
    v_mul_f32 v79, v236, v79
    v_cvt_pk_bf16_f32 v118, v76, v77
    v_cvt_pk_bf16_f32 v119, v78, v79
    ds_write_b64 v226, v[116:117] offset:4096
    v_accvgpr_read_b32 v88, a100
    v_accvgpr_read_b32 v89, a101
    v_accvgpr_read_b32 v90, a102
    v_mfma_f32_16x16x32_bf16 a[72:75], a[164:167], v[148:151], a[72:75]
    v_accvgpr_read_b32 v91, a103
    v_mul_f32 v80, v236, v80
    v_mul_f32 v81, v236, v81
    v_mul_f32 v82, v236, v82
    v_mul_f32 v83, v236, v83
    v_cvt_pk_bf16_f32 v120, v80, v81
    v_cvt_pk_bf16_f32 v121, v82, v83
    v_mfma_f32_16x16x32_bf16 a[88:91], a[168:171], v[144:147], a[88:91]
    ds_write_b64 v227, v[118:119] offset:4096
    v_mfma_f32_16x16x32_bf16 a[244:247], a[248:251], v[116:119], a[244:247]
    v_accvgpr_read_b32 v92, a116
    v_accvgpr_read_b32 v93, a117
    v_accvgpr_read_b32 v94, a118
    s_waitcnt lgkmcnt(4)
    s_mov_b32 s62, 0
    v_mfma_f32_16x16x32_bf16 a[88:91], a[172:175], v[148:151], a[88:91]
    buffer_store_dwordx4 v[32:35], v246, s[36:39], s62 offen sc0 sc1
    s_mov_b32 s62, 1024
    buffer_store_dwordx4 v[36:39], v246, s[36:39], s62 offen sc0 sc1
    s_mov_b32 s62, 524288
    buffer_store_dwordx4 v[40:43], v246, s[36:39], s62 offen sc0 sc1
    s_mov_b32 s62, 525312
    v_mfma_f32_16x16x32_bf16 a[104:107], a[176:179], v[144:147], a[104:107]
    buffer_store_dwordx4 v[44:47], v246, s[36:39], s62 offen sc0 sc1
    v_accvgpr_read_b32 v95, a119
    v_mul_f32 v84, v236, v84
    v_mul_f32 v85, v236, v85
    v_mul_f32 v86, v236, v86
    v_mul_f32 v87, v236, v87
    v_cvt_pk_bf16_f32 v122, v84, v85
    v_mfma_f32_16x16x32_bf16 a[104:107], a[180:183], v[148:151], a[104:107]
    v_cvt_pk_bf16_f32 v123, v86, v87
    ds_write_b64 v228, v[120:121] offset:4096
    v_mul_f32 v88, v236, v88
    v_mul_f32 v89, v236, v89
    v_mul_f32 v90, v236, v90
    v_mul_f32 v91, v236, v91
    v_cvt_pk_bf16_f32 v124, v88, v89
    v_mfma_f32_16x16x32_bf16 a[120:123], a[204:207], v[144:147], a[120:123]
    v_cvt_pk_bf16_f32 v125, v90, v91
    ds_write_b64 v229, v[122:123] offset:4096
    v_mfma_f32_16x16x32_bf16 a[244:247], a[248:251], v[120:123], a[244:247]
    v_mul_f32 v92, v236, v92
    v_mul_f32 v93, v236, v93
    v_mul_f32 v94, v236, v94
    v_mul_f32 v95, v236, v95
    v_mfma_f32_16x16x32_bf16 a[120:123], a[208:211], v[148:151], a[120:123]
    v_cvt_pk_bf16_f32 v126, v92, v93
    v_cvt_pk_bf16_f32 v127, v94, v95
    ds_write_b64 v230, v[124:125] offset:4096
    ds_write_b64 v231, v[126:127] offset:4096
    s_nop 0
    v_mfma_f32_16x16x32_bf16 a[244:247], a[248:251], v[124:127], a[244:247]
    v_smfmac_f32_16x16x64_bf16 a[196:199], a[200:203], v[152:159], v18
    v_accvgpr_read_b32 v236, a192
    v_accvgpr_read_b32 v237, a193
    v_accvgpr_read_b32 v32, a8
    v_add_f32 v236, v236, v237
    v_accvgpr_read_b32 v33, a9
    v_cmp_lt_f32 vcc, s64, v236
    v_accvgpr_read_b32 v34, a10
    v_mfma_f32_16x16x32_bf16 a[12:15], a[128:131], v[152:155], a[12:15]
    v_accvgpr_read_b32 v35, a11
    s_and_b64 s[70:71], s[70:71], vcc
    v_cmp_gt_f32 vcc, s65, v236
    v_rcp_f32 v236, v236
    v_accvgpr_read_b32 v36, a24
    v_accvgpr_read_b32 v37, a25
    s_and_b64 s[70:71], s[70:71], vcc
    v_mfma_f32_16x16x32_bf16 a[12:15], a[132:135], v[156:159], a[12:15]
    v_accvgpr_read_b32 v38, a26
    v_accvgpr_read_b32 v39, a27
    v_accvgpr_read_b32 v40, a40
    v_accvgpr_read_b32 v41, a41
    v_accvgpr_read_b32 v42, a42
    v_accvgpr_read_b32 v43, a43
    v_mul_f32 v32, v236, v32
    v_mfma_f32_16x16x32_bf16 a[28:31], a[136:139], v[152:155], a[28:31]
    v_mul_f32 v33, v236, v33
    v_mul_f32 v34, v236, v34
    v_mul_f32 v35, v236, v35
    v_cvt_pk_bf16_f32 v96, v32, v33
    s_waitcnt lgkmcnt(0)
    ds_read_b128 v[64:67], v232 offset:4096
    ds_read_b128 v[68:71], v233 offset:5120
    v_mfma_f32_16x16x32_bf16 a[28:31], a[140:143], v[156:159], a[28:31]
    ds_read_b128 v[72:75], v234 offset:6144
    ds_read_b128 v[76:79], v235 offset:7168
    v_cvt_pk_bf16_f32 v97, v34, v35
    v_accvgpr_read_b32 v44, a56
    v_accvgpr_read_b32 v45, a57
    v_accvgpr_read_b32 v46, a58
    v_mfma_f32_16x16x32_bf16 a[44:47], a[144:147], v[152:155], a[44:47]
    v_accvgpr_read_b32 v47, a59
    v_mul_f32 v36, v236, v36
    v_mul_f32 v37, v236, v37
    v_mul_f32 v38, v236, v38
    v_mul_f32 v39, v236, v39
    v_cvt_pk_bf16_f32 v98, v36, v37
    v_cvt_pk_bf16_f32 v99, v38, v39
    v_mfma_f32_16x16x32_bf16 a[44:47], a[148:151], v[156:159], a[44:47]
    ds_write_b64 v224, v[96:97] offset:8192
    v_accvgpr_read_b32 v48, a72
    v_accvgpr_read_b32 v49, a73
    v_accvgpr_read_b32 v50, a74
    v_accvgpr_read_b32 v51, a75
    v_mul_f32 v40, v236, v40
    v_mul_f32 v41, v236, v41
    v_mfma_f32_16x16x32_bf16 a[60:63], a[152:155], v[152:155], a[60:63]
    v_mul_f32 v42, v236, v42
    v_mul_f32 v43, v236, v43
    v_cvt_pk_bf16_f32 v100, v40, v41
    v_cvt_pk_bf16_f32 v101, v42, v43
    ds_write_b64 v225, v[98:99] offset:8192
    v_mfma_f32_16x16x32_bf16 a[244:247], a[248:251], v[96:99], a[244:247]
    v_accvgpr_read_b32 v52, a88
    v_mfma_f32_16x16x32_bf16 a[60:63], a[156:159], v[156:159], a[60:63]
    v_accvgpr_read_b32 v53, a89
    v_accvgpr_read_b32 v54, a90
    v_accvgpr_read_b32 v55, a91
    v_mul_f32 v44, v236, v44
    v_mul_f32 v45, v236, v45
    v_mul_f32 v46, v236, v46
    v_mfma_f32_16x16x32_bf16 a[76:79], a[160:163], v[152:155], a[76:79]
    v_mul_f32 v47, v236, v47
    v_cvt_pk_bf16_f32 v102, v44, v45
    v_cvt_pk_bf16_f32 v103, v46, v47
    ds_write_b64 v226, v[100:101] offset:8192
    v_accvgpr_read_b32 v56, a104
    v_accvgpr_read_b32 v57, a105
    v_accvgpr_read_b32 v58, a106
    v_mfma_f32_16x16x32_bf16 a[76:79], a[164:167], v[156:159], a[76:79]
    v_accvgpr_read_b32 v59, a107
    v_mul_f32 v48, v236, v48
    v_mul_f32 v49, v236, v49
    v_mul_f32 v50, v236, v50
    v_mul_f32 v51, v236, v51
    v_cvt_pk_bf16_f32 v104, v48, v49
    v_cvt_pk_bf16_f32 v105, v50, v51
    v_mfma_f32_16x16x32_bf16 a[92:95], a[168:171], v[152:155], a[92:95]
    ds_write_b64 v227, v[102:103] offset:8192
    v_mfma_f32_16x16x32_bf16 a[244:247], a[248:251], v[100:103], a[244:247]
    v_accvgpr_read_b32 v60, a120
    v_accvgpr_read_b32 v61, a121
    v_accvgpr_read_b32 v62, a122
    s_waitcnt lgkmcnt(4)
    s_mov_b32 s62, 2048
    v_mfma_f32_16x16x32_bf16 a[92:95], a[172:175], v[156:159], a[92:95]
    buffer_store_dwordx4 v[64:67], v246, s[36:39], s62 offen sc0 sc1
    s_mov_b32 s62, 3072
    buffer_store_dwordx4 v[68:71], v246, s[36:39], s62 offen sc0 sc1
    s_mov_b32 s62, 526336
    buffer_store_dwordx4 v[72:75], v246, s[36:39], s62 offen sc0 sc1
    s_mov_b32 s62, 527360
    v_mfma_f32_16x16x32_bf16 a[108:111], a[176:179], v[152:155], a[108:111]
    buffer_store_dwordx4 v[76:79], v246, s[36:39], s62 offen sc0 sc1
    v_accvgpr_read_b32 v63, a123
    v_mul_f32 v52, v236, v52
    v_mul_f32 v53, v236, v53
    v_mul_f32 v54, v236, v54
    v_mul_f32 v55, v236, v55
    v_cvt_pk_bf16_f32 v106, v52, v53
    v_mfma_f32_16x16x32_bf16 a[108:111], a[180:183], v[156:159], a[108:111]
    v_cvt_pk_bf16_f32 v107, v54, v55
    ds_write_b64 v228, v[104:105] offset:8192
    v_mul_f32 v56, v236, v56
    v_mul_f32 v57, v236, v57
    v_mul_f32 v58, v236, v58
    v_mul_f32 v59, v236, v59
    v_cvt_pk_bf16_f32 v108, v56, v57
    v_mfma_f32_16x16x32_bf16 a[124:127], a[204:207], v[152:155], a[124:127]
    v_cvt_pk_bf16_f32 v109, v58, v59
    ds_write_b64 v229, v[106:107] offset:8192
    v_mfma_f32_16x16x32_bf16 a[244:247], a[248:251], v[104:107], a[244:247]
    v_mul_f32 v60, v236, v60
    v_mul_f32 v61, v236, v61
    v_mul_f32 v62, v236, v62
    v_mul_f32 v63, v236, v63
    v_mfma_f32_16x16x32_bf16 a[124:127], a[208:211], v[156:159], a[124:127]
    v_cvt_pk_bf16_f32 v110, v60, v61
    v_cvt_pk_bf16_f32 v111, v62, v63
    ds_write_b64 v230, v[108:109] offset:8192
    ds_write_b64 v231, v[110:111] offset:8192
    s_nop 0
    v_mfma_f32_16x16x32_bf16 a[244:247], a[248:251], v[108:111], a[244:247]
    s_nop 3
    v_accvgpr_read_b32 v236, a196
    v_accvgpr_read_b32 v237, a197
    v_accvgpr_read_b32 v64, a12
    v_add_f32 v236, v236, v237
    v_accvgpr_read_b32 v65, a13
    v_cmp_lt_f32 vcc, s64, v236
    v_accvgpr_read_b32 v66, a14
    v_accvgpr_read_b32 v67, a15
    s_and_b64 s[70:71], s[70:71], vcc
    v_cmp_gt_f32 vcc, s65, v236
    v_rcp_f32 v236, v236
    v_accvgpr_read_b32 v68, a28
    v_accvgpr_read_b32 v69, a29
    s_and_b64 s[70:71], s[70:71], vcc
    v_accvgpr_read_b32 v70, a30
    v_accvgpr_read_b32 v71, a31
    v_accvgpr_read_b32 v72, a44
    v_accvgpr_read_b32 v73, a45
    v_accvgpr_read_b32 v74, a46
    v_accvgpr_read_b32 v75, a47
    v_mul_f32 v64, v236, v64
    v_mul_f32 v65, v236, v65
    v_mul_f32 v66, v236, v66
    v_mul_f32 v67, v236, v67
    v_cvt_pk_bf16_f32 v112, v64, v65
    s_waitcnt lgkmcnt(0)
    ds_read_b128 v[32:35], v232 offset:8192
    ds_read_b128 v[36:39], v233 offset:9216
    ds_read_b128 v[40:43], v234 offset:10240
    ds_read_b128 v[44:47], v235 offset:11264
    v_cvt_pk_bf16_f32 v113, v66, v67
    v_accvgpr_read_b32 v76, a60
    v_accvgpr_read_b32 v77, a61
    v_accvgpr_read_b32 v78, a62
    v_accvgpr_read_b32 v79, a63
    v_mul_f32 v68, v236, v68
    v_mul_f32 v69, v236, v69
    v_mul_f32 v70, v236, v70
    v_mul_f32 v71, v236, v71
    v_cvt_pk_bf16_f32 v114, v68, v69
    v_cvt_pk_bf16_f32 v115, v70, v71
    ds_write_b64 v224, v[112:113] offset:12288
    v_accvgpr_read_b32 v80, a76
    v_accvgpr_read_b32 v81, a77
    v_accvgpr_read_b32 v82, a78
    v_accvgpr_read_b32 v83, a79
    v_mul_f32 v72, v236, v72
    v_mul_f32 v73, v236, v73
    v_mul_f32 v74, v236, v74
    v_mul_f32 v75, v236, v75
    v_cvt_pk_bf16_f32 v116, v72, v73
    v_cvt_pk_bf16_f32 v117, v74, v75
    ds_write_b64 v225, v[114:115] offset:12288
    v_mfma_f32_16x16x32_bf16 a[244:247], a[248:251], v[112:115], a[244:247]
    v_accvgpr_read_b32 v84, a92
    v_accvgpr_read_b32 v85, a93
    v_accvgpr_read_b32 v86, a94
    v_accvgpr_read_b32 v87, a95
    v_mul_f32 v76, v236, v76
    v_mul_f32 v77, v236, v77
    v_mul_f32 v78, v236, v78
    v_mul_f32 v79, v236, v79
    v_cvt_pk_bf16_f32 v118, v76, v77
    v_cvt_pk_bf16_f32 v119, v78, v79
    ds_write_b64 v226, v[116:117] offset:12288
    v_accvgpr_read_b32 v88, a108
    v_accvgpr_read_b32 v89, a109
    v_accvgpr_read_b32 v90, a110
    v_accvgpr_read_b32 v91, a111
    v_mul_f32 v80, v236, v80
    v_mul_f32 v81, v236, v81
    v_mul_f32 v82, v236, v82
    v_mul_f32 v83, v236, v83
    v_cvt_pk_bf16_f32 v120, v80, v81
    v_cvt_pk_bf16_f32 v121, v82, v83
    ds_write_b64 v227, v[118:119] offset:12288
    v_mfma_f32_16x16x32_bf16 a[244:247], a[248:251], v[116:119], a[244:247]
    v_accvgpr_read_b32 v92, a124
    v_accvgpr_read_b32 v93, a125
    v_accvgpr_read_b32 v94, a126
    s_waitcnt lgkmcnt(4)
    s_mov_b32 s62, 4096
    buffer_store_dwordx4 v[32:35], v246, s[36:39], s62 offen sc0 sc1
    s_mov_b32 s62, 5120
    buffer_store_dwordx4 v[36:39], v246, s[36:39], s62 offen sc0 sc1
    s_mov_b32 s62, 528384
    buffer_store_dwordx4 v[40:43], v246, s[36:39], s62 offen sc0 sc1
    s_mov_b32 s62, 529408
    buffer_store_dwordx4 v[44:47], v246, s[36:39], s62 offen sc0 sc1
    v_accvgpr_read_b32 v95, a127
    v_mul_f32 v84, v236, v84
    v_mul_f32 v85, v236, v85
    v_mul_f32 v86, v236, v86
    v_mul_f32 v87, v236, v87
    v_cvt_pk_bf16_f32 v122, v84, v85
    v_cvt_pk_bf16_f32 v123, v86, v87
    ds_write_b64 v228, v[120:121] offset:12288
    v_mul_f32 v88, v236, v88
    v_mul_f32 v89, v236, v89
    v_mul_f32 v90, v236, v90
    v_mul_f32 v91, v236, v91
    v_cvt_pk_bf16_f32 v124, v88, v89
    v_cvt_pk_bf16_f32 v125, v90, v91
    ds_write_b64 v229, v[122:123] offset:12288
    v_mfma_f32_16x16x32_bf16 a[244:247], a[248:251], v[120:123], a[244:247]
    v_mul_f32 v92, v236, v92
    v_mul_f32 v93, v236, v93
    v_mul_f32 v94, v236, v94
    v_mul_f32 v95, v236, v95
    v_cvt_pk_bf16_f32 v126, v92, v93
    v_cvt_pk_bf16_f32 v127, v94, v95
    ds_write_b64 v230, v[124:125] offset:12288
    ds_write_b64 v231, v[126:127] offset:12288
    s_nop 0
    v_mfma_f32_16x16x32_bf16 a[244:247], a[248:251], v[124:127], a[244:247]
    s_waitcnt lgkmcnt(0)
    ds_read_b128 v[64:67], v232 offset:12288
    ds_read_b128 v[68:71], v233 offset:13312
    ds_read_b128 v[72:75], v234 offset:14336
    ds_read_b128 v[76:79], v235 offset:15360
    s_nop 2
    v_accvgpr_read_b32 v128, a244
    v_accvgpr_read_b32 v129, a245
    v_accvgpr_read_b32 v130, a246
    v_accvgpr_read_b32 v131, a247
    s_mov_b32 s64, 0x207
    s_waitcnt lgkmcnt(0)
    s_mov_b32 s62, 6144
    buffer_store_dwordx4 v[64:67], v246, s[36:39], s62 offen sc0 sc1
    s_mov_b32 s62, 7168
    buffer_store_dwordx4 v[68:71], v246, s[36:39], s62 offen sc0 sc1
    s_mov_b32 s62, 530432
    buffer_store_dwordx4 v[72:75], v246, s[36:39], s62 offen sc0 sc1
    s_mov_b32 s62, 531456
    buffer_store_dwordx4 v[76:79], v246, s[36:39], s62 offen sc0 sc1
    v_cmp_class_f32 vcc, v128, s64
    s_mov_b64 s[74:75], 0
    s_nop 0
    s_or_b64 s[74:75], s[74:75], vcc
    v_cmp_class_f32 vcc, v129, s64
    s_nop 0
    s_or_b64 s[74:75], s[74:75], vcc
    v_cmp_class_f32 vcc, v130, s64
    s_nop 0
    s_or_b64 s[74:75], s[74:75], vcc
    v_cmp_class_f32 vcc, v131, s64
    s_nop 0
    s_or_b64 s[74:75], s[74:75], vcc
    s_xor_b64 s[70:71], s[70:71], exec
    s_or_b64 s[74:75], s[74:75], s[70:71]
    s_cmp_lg_u64 s[74:75], 0
    s_cbranch_scc1 L_slow_standalone__tree_speculative_verify_tree_attention_over_candidate_token_tree__prompt_kernel
L_fin_standalone__tree_speculative_verify_tree_attention_over_candidate_token_tree__prompt_kernel:
    s_waitcnt vmcnt(0)
L_end_standalone__tree_speculative_verify_tree_attention_over_candidate_token_tree__prompt_kernel:
    s_endpgm
L_slow_standalone__tree_speculative_verify_tree_attention_over_candidate_token_tree__prompt_kernel:
    s_waitcnt vmcnt(0) lgkmcnt(0)
    v_lshrrev_b32 v57, 4, v246
    v_xor_b32 v54, 16, v57
    v_lshlrev_b32 v54, 2, v54
    v_xor_b32 v55, 32, v57
    v_lshlrev_b32 v55, 2, v55
    v_and_b32 v58, 7, v57
    v_lshlrev_b32 v58, 12, v58
    v_lshrrev_b32 v59, 4, v57
    v_lshl_add_u32 v56, v59, 3, v58
    v_subrev_u32 v44, s58, v14
    v_subrev_u32 v45, s58, v15
    s_mov_b32 s88, s14
    s_and_b32 s89, s15, 0xffff
    s_mov_b32 s90, 0x800000
    s_mov_b32 s91, 0x20000
    v_mov_b32 v52, 0xff800000
    v_mov_b32 v53, 0
    v_accvgpr_write_b32 a0, 0
    v_accvgpr_write_b32 a1, 0
    v_accvgpr_write_b32 a2, 0
    v_accvgpr_write_b32 a3, 0
    v_accvgpr_write_b32 a16, 0
    v_accvgpr_write_b32 a17, 0
    v_accvgpr_write_b32 a18, 0
    v_accvgpr_write_b32 a19, 0
    v_accvgpr_write_b32 a32, 0
    v_accvgpr_write_b32 a33, 0
    v_accvgpr_write_b32 a34, 0
    v_accvgpr_write_b32 a35, 0
    v_accvgpr_write_b32 a48, 0
    v_accvgpr_write_b32 a49, 0
    v_accvgpr_write_b32 a50, 0
    v_accvgpr_write_b32 a51, 0
    v_accvgpr_write_b32 a64, 0
    v_accvgpr_write_b32 a65, 0
    v_accvgpr_write_b32 a66, 0
    v_accvgpr_write_b32 a67, 0
    v_accvgpr_write_b32 a80, 0
    v_accvgpr_write_b32 a81, 0
    v_accvgpr_write_b32 a82, 0
    v_accvgpr_write_b32 a83, 0
    v_accvgpr_write_b32 a96, 0
    v_accvgpr_write_b32 a97, 0
    v_accvgpr_write_b32 a98, 0
    v_accvgpr_write_b32 a99, 0
    v_accvgpr_write_b32 a112, 0
    v_accvgpr_write_b32 a113, 0
    v_accvgpr_write_b32 a114, 0
    v_accvgpr_write_b32 a115, 0
    s_mov_b32 s76, 0
L_slowl0_standalone__tree_speculative_verify_tree_attention_over_candidate_token_tree__prompt_kernel:
    s_cmp_lt_u32 s76, 64
    s_cselect_b32 s64, s24, s40
    s_cselect_b32 s72, s28, s44
    s_cselect_b32 s65, s25, s41
    s_cselect_b32 s73, s29, s45
    s_mov_b32 s66, 524288
    s_mov_b32 s67, 0x20000
    s_mov_b32 s74, 524288
    s_mov_b32 s75, 0x20000
    s_and_b32 s77, s76, 63
    s_lshl_b32 s77, s77, 13
    s_add_u32 m0, s78, 0
    s_add_u32 s60, s77, 0
    buffer_load_dwordx4 v44, s[64:67], s60 offen lds
    s_add_u32 m0, s78, 1024
    s_add_u32 s60, s77, 1024
    buffer_load_dwordx4 v45, s[64:67], s60 offen lds
    s_add_u32 m0, s78, 2048
    s_add_u32 s60, s77, 2048
    buffer_load_dwordx4 v44, s[64:67], s60 offen lds
    s_add_u32 m0, s78, 3072
    s_add_u32 s60, s77, 3072
    buffer_load_dwordx4 v45, s[64:67], s60 offen lds
    s_add_u32 m0, s78, 4096
    s_add_u32 s60, s77, 4096
    buffer_load_dwordx4 v44, s[64:67], s60 offen lds
    s_add_u32 m0, s78, 5120
    s_add_u32 s60, s77, 5120
    buffer_load_dwordx4 v45, s[64:67], s60 offen lds
    s_add_u32 m0, s78, 6144
    s_add_u32 s60, s77, 6144
    buffer_load_dwordx4 v44, s[64:67], s60 offen lds
    s_add_u32 m0, s78, 7168
    s_add_u32 s60, s77, 7168
    buffer_load_dwordx4 v45, s[64:67], s60 offen lds
    s_add_u32 m0, s78, 8192
    s_add_u32 s60, s77, 0
    buffer_load_dwordx4 v44, s[72:75], s60 offen lds
    s_add_u32 m0, s78, 9216
    s_add_u32 s60, s77, 1024
    buffer_load_dwordx4 v45, s[72:75], s60 offen lds
    s_add_u32 m0, s78, 10240
    s_add_u32 s60, s77, 2048
    buffer_load_dwordx4 v44, s[72:75], s60 offen lds
    s_add_u32 m0, s78, 11264
    s_add_u32 s60, s77, 3072
    buffer_load_dwordx4 v45, s[72:75], s60 offen lds
    s_add_u32 m0, s78, 12288
    s_add_u32 s60, s77, 4096
    buffer_load_dwordx4 v44, s[72:75], s60 offen lds
    s_add_u32 m0, s78, 13312
    s_add_u32 s60, s77, 5120
    buffer_load_dwordx4 v45, s[72:75], s60 offen lds
    s_add_u32 m0, s78, 14336
    s_add_u32 s60, s77, 6144
    buffer_load_dwordx4 v44, s[72:75], s60 offen lds
    s_add_u32 m0, s78, 15360
    s_add_u32 s60, s77, 7168
    buffer_load_dwordx4 v45, s[72:75], s60 offen lds
    s_add_u32 s60, s59, 0
    s_lshl_b32 s60, s60, 12
    s_lshr_b32 s61, s77, 7
    s_add_u32 s60, s60, s61
    buffer_load_dwordx2 v[48:49], v56, s[88:91], s60 offen
    buffer_load_dwordx2 v[50:51], v56, s[88:91], s60 offen offset:32
    s_waitcnt vmcnt(0)
    ds_read_b128 a[204:207], v21 offset:0
    ds_read_b128 a[208:211], v22 offset:0
    ds_read_b128 a[212:215], v23 offset:0
    ds_read_b128 a[216:219], v24 offset:0
    ds_read_b128 a[220:223], v21 offset:4096
    ds_read_b128 a[224:227], v22 offset:4096
    ds_read_b128 a[228:231], v23 offset:4096
    ds_read_b128 a[232:235], v24 offset:4096
    s_waitcnt lgkmcnt(0)
    ds_read_b64_tr_b16 a[160:161], v25 offset:8192
    ds_read_b64_tr_b16 a[162:163], v25 offset:12288
    ds_read_b64_tr_b16 a[164:165], v26 offset:8192
    ds_read_b64_tr_b16 a[166:167], v26 offset:12288
    ds_read_b64_tr_b16 a[168:169], v27 offset:8192
    ds_read_b64_tr_b16 a[170:171], v27 offset:12288
    ds_read_b64_tr_b16 a[172:173], v28 offset:8192
    ds_read_b64_tr_b16 a[174:175], v28 offset:12288
    ds_read_b64_tr_b16 a[176:177], v29 offset:8192
    ds_read_b64_tr_b16 a[178:179], v29 offset:12288
    ds_read_b64_tr_b16 a[180:181], v30 offset:8192
    ds_read_b64_tr_b16 a[182:183], v30 offset:12288
    ds_read_b64_tr_b16 a[236:237], v31 offset:8192
    ds_read_b64_tr_b16 a[238:239], v31 offset:12288
    ds_read_b64_tr_b16 a[240:241], v0 offset:8192
    ds_read_b64_tr_b16 a[242:243], v0 offset:12288
    v_mfma_f32_16x16x32_bf16 v[32:35], a[204:207], v[160:163], 0
    v_mfma_f32_16x16x32_bf16 v[32:35], a[208:211], v[164:167], v[32:35]
    v_mfma_f32_16x16x32_bf16 v[32:35], a[212:215], v[168:171], v[32:35]
    v_mfma_f32_16x16x32_bf16 v[32:35], a[216:219], v[172:175], v[32:35]
    v_mfma_f32_16x16x32_bf16 v[36:39], a[220:223], v[160:163], 0
    v_mfma_f32_16x16x32_bf16 v[36:39], a[224:227], v[164:167], v[36:39]
    v_mfma_f32_16x16x32_bf16 v[36:39], a[228:231], v[168:171], v[36:39]
    v_mfma_f32_16x16x32_bf16 v[36:39], a[232:235], v[172:175], v[36:39]
    s_nop 7
    s_cmp_lt_u32 s76, 64
    s_cbranch_scc1 L_nomask0_standalone__tree_speculative_verify_tree_attention_over_candidate_token_tree__prompt_kernel
    s_mov_b32 s60, 0x3f80
    v_mov_b32 v59, 0xff800000
    v_and_b32 v57, 0xffff, v48
    v_cmp_eq_u32 vcc, s60, v57
    s_nop 1
    v_cndmask_b32 v32, v59, v32, vcc
    v_lshrrev_b32 v57, 16, v48
    v_cmp_eq_u32 vcc, s60, v57
    s_nop 1
    v_cndmask_b32 v33, v59, v33, vcc
    v_and_b32 v57, 0xffff, v49
    v_cmp_eq_u32 vcc, s60, v57
    s_nop 1
    v_cndmask_b32 v34, v59, v34, vcc
    v_lshrrev_b32 v57, 16, v49
    v_cmp_eq_u32 vcc, s60, v57
    s_nop 1
    v_cndmask_b32 v35, v59, v35, vcc
    v_and_b32 v57, 0xffff, v50
    v_cmp_eq_u32 vcc, s60, v57
    s_nop 1
    v_cndmask_b32 v36, v59, v36, vcc
    v_lshrrev_b32 v57, 16, v50
    v_cmp_eq_u32 vcc, s60, v57
    s_nop 1
    v_cndmask_b32 v37, v59, v37, vcc
    v_and_b32 v57, 0xffff, v51
    v_cmp_eq_u32 vcc, s60, v57
    s_nop 1
    v_cndmask_b32 v38, v59, v38, vcc
    v_lshrrev_b32 v57, 16, v51
    v_cmp_eq_u32 vcc, s60, v57
    s_nop 1
    v_cndmask_b32 v39, v59, v39, vcc
L_nomask0_standalone__tree_speculative_verify_tree_attention_over_candidate_token_tree__prompt_kernel:
    v_max3_f32 v57, v32, v33, v34
    v_max3_f32 v57, v57, v35, v36
    v_max3_f32 v57, v57, v37, v38
    v_max_f32 v57, v57, v39
    ds_bpermute_b32 v58, v54, v57
    s_waitcnt lgkmcnt(0)
    v_max_f32 v57, v57, v58
    ds_bpermute_b32 v58, v55, v57
    s_waitcnt lgkmcnt(0)
    v_max_f32 v57, v57, v58
    v_max_f32 v57, v57, v52
    v_sub_f32 v58, v52, v57
    v_exp_f32 v58, v58
    v_mov_b32 v52, v57
    v_sub_f32 v32, v32, v52
    v_exp_f32 v32, v32
    v_sub_f32 v33, v33, v52
    v_exp_f32 v33, v33
    v_sub_f32 v34, v34, v52
    v_exp_f32 v34, v34
    v_sub_f32 v35, v35, v52
    v_exp_f32 v35, v35
    v_sub_f32 v36, v36, v52
    v_exp_f32 v36, v36
    v_sub_f32 v37, v37, v52
    v_exp_f32 v37, v37
    v_sub_f32 v38, v38, v52
    v_exp_f32 v38, v38
    v_sub_f32 v39, v39, v52
    v_exp_f32 v39, v39
    v_mul_f32 v53, v53, v58
    v_add_f32 v53, v53, v32
    v_add_f32 v53, v53, v33
    v_add_f32 v53, v53, v34
    v_add_f32 v53, v53, v35
    v_add_f32 v53, v53, v36
    v_add_f32 v53, v53, v37
    v_add_f32 v53, v53, v38
    v_add_f32 v53, v53, v39
    v_accvgpr_read_b32 v59, a0
    v_mul_f32 v59, v59, v58
    v_accvgpr_write_b32 a0, v59
    v_accvgpr_read_b32 v59, a1
    v_mul_f32 v59, v59, v58
    v_accvgpr_write_b32 a1, v59
    v_accvgpr_read_b32 v59, a2
    v_mul_f32 v59, v59, v58
    v_accvgpr_write_b32 a2, v59
    v_accvgpr_read_b32 v59, a3
    v_mul_f32 v59, v59, v58
    v_accvgpr_write_b32 a3, v59
    v_accvgpr_read_b32 v59, a16
    v_mul_f32 v59, v59, v58
    v_accvgpr_write_b32 a16, v59
    v_accvgpr_read_b32 v59, a17
    v_mul_f32 v59, v59, v58
    v_accvgpr_write_b32 a17, v59
    v_accvgpr_read_b32 v59, a18
    v_mul_f32 v59, v59, v58
    v_accvgpr_write_b32 a18, v59
    v_accvgpr_read_b32 v59, a19
    v_mul_f32 v59, v59, v58
    v_accvgpr_write_b32 a19, v59
    v_accvgpr_read_b32 v59, a32
    v_mul_f32 v59, v59, v58
    v_accvgpr_write_b32 a32, v59
    v_accvgpr_read_b32 v59, a33
    v_mul_f32 v59, v59, v58
    v_accvgpr_write_b32 a33, v59
    v_accvgpr_read_b32 v59, a34
    v_mul_f32 v59, v59, v58
    v_accvgpr_write_b32 a34, v59
    v_accvgpr_read_b32 v59, a35
    v_mul_f32 v59, v59, v58
    v_accvgpr_write_b32 a35, v59
    v_accvgpr_read_b32 v59, a48
    v_mul_f32 v59, v59, v58
    v_accvgpr_write_b32 a48, v59
    v_accvgpr_read_b32 v59, a49
    v_mul_f32 v59, v59, v58
    v_accvgpr_write_b32 a49, v59
    v_accvgpr_read_b32 v59, a50
    v_mul_f32 v59, v59, v58
    v_accvgpr_write_b32 a50, v59
    v_accvgpr_read_b32 v59, a51
    v_mul_f32 v59, v59, v58
    v_accvgpr_write_b32 a51, v59
    v_accvgpr_read_b32 v59, a64
    v_mul_f32 v59, v59, v58
    v_accvgpr_write_b32 a64, v59
    v_accvgpr_read_b32 v59, a65
    v_mul_f32 v59, v59, v58
    v_accvgpr_write_b32 a65, v59
    v_accvgpr_read_b32 v59, a66
    v_mul_f32 v59, v59, v58
    v_accvgpr_write_b32 a66, v59
    v_accvgpr_read_b32 v59, a67
    v_mul_f32 v59, v59, v58
    v_accvgpr_write_b32 a67, v59
    v_accvgpr_read_b32 v59, a80
    v_mul_f32 v59, v59, v58
    v_accvgpr_write_b32 a80, v59
    v_accvgpr_read_b32 v59, a81
    v_mul_f32 v59, v59, v58
    v_accvgpr_write_b32 a81, v59
    v_accvgpr_read_b32 v59, a82
    v_mul_f32 v59, v59, v58
    v_accvgpr_write_b32 a82, v59
    v_accvgpr_read_b32 v59, a83
    v_mul_f32 v59, v59, v58
    v_accvgpr_write_b32 a83, v59
    v_accvgpr_read_b32 v59, a96
    v_mul_f32 v59, v59, v58
    v_accvgpr_write_b32 a96, v59
    v_accvgpr_read_b32 v59, a97
    v_mul_f32 v59, v59, v58
    v_accvgpr_write_b32 a97, v59
    v_accvgpr_read_b32 v59, a98
    v_mul_f32 v59, v59, v58
    v_accvgpr_write_b32 a98, v59
    v_accvgpr_read_b32 v59, a99
    v_mul_f32 v59, v59, v58
    v_accvgpr_write_b32 a99, v59
    v_accvgpr_read_b32 v59, a112
    v_mul_f32 v59, v59, v58
    v_accvgpr_write_b32 a112, v59
    v_accvgpr_read_b32 v59, a113
    v_mul_f32 v59, v59, v58
    v_accvgpr_write_b32 a113, v59
    v_accvgpr_read_b32 v59, a114
    v_mul_f32 v59, v59, v58
    v_accvgpr_write_b32 a114, v59
    v_accvgpr_read_b32 v59, a115
    v_mul_f32 v59, v59, v58
    v_accvgpr_write_b32 a115, v59
    v_cvt_pk_bf16_f32 v40, v32, v33
    v_cvt_pk_bf16_f32 v41, v34, v35
    v_cvt_pk_bf16_f32 v42, v36, v37
    v_cvt_pk_bf16_f32 v43, v38, v39
    s_waitcnt lgkmcnt(0)
    s_nop 1
    v_mfma_f32_16x16x32_bf16 a[0:3], a[160:163], v[40:43], a[0:3]
    v_mfma_f32_16x16x32_bf16 a[16:19], a[164:167], v[40:43], a[16:19]
    v_mfma_f32_16x16x32_bf16 a[32:35], a[168:171], v[40:43], a[32:35]
    v_mfma_f32_16x16x32_bf16 a[48:51], a[172:175], v[40:43], a[48:51]
    v_mfma_f32_16x16x32_bf16 a[64:67], a[176:179], v[40:43], a[64:67]
    v_mfma_f32_16x16x32_bf16 a[80:83], a[180:183], v[40:43], a[80:83]
    v_mfma_f32_16x16x32_bf16 a[96:99], a[236:239], v[40:43], a[96:99]
    v_mfma_f32_16x16x32_bf16 a[112:115], a[240:243], v[40:43], a[112:115]
    s_nop 7
    s_add_u32 s76, s76, 1
    s_cmp_lt_u32 s76, 128
    s_cbranch_scc1 L_slowl0_standalone__tree_speculative_verify_tree_attention_over_candidate_token_tree__prompt_kernel
    ds_bpermute_b32 v58, v54, v53
    s_waitcnt lgkmcnt(0)
    v_add_f32 v53, v53, v58
    ds_bpermute_b32 v58, v55, v53
    s_waitcnt lgkmcnt(0)
    v_add_f32 v53, v53, v58
    v_accvgpr_write_b32 a184, v53
    v_accvgpr_write_b32 a185, 0
    v_lshrrev_b32 v57, 4, v246
    v_xor_b32 v54, 16, v57
    v_lshlrev_b32 v54, 2, v54
    v_xor_b32 v55, 32, v57
    v_lshlrev_b32 v55, 2, v55
    v_and_b32 v58, 7, v57
    v_lshlrev_b32 v58, 12, v58
    v_lshrrev_b32 v59, 4, v57
    v_lshl_add_u32 v56, v59, 3, v58
    v_subrev_u32 v44, s58, v14
    v_subrev_u32 v45, s58, v15
    s_mov_b32 s88, s14
    s_and_b32 s89, s15, 0xffff
    s_mov_b32 s90, 0x800000
    s_mov_b32 s91, 0x20000
    v_mov_b32 v52, 0xff800000
    v_mov_b32 v53, 0
    v_accvgpr_write_b32 a4, 0
    v_accvgpr_write_b32 a5, 0
    v_accvgpr_write_b32 a6, 0
    v_accvgpr_write_b32 a7, 0
    v_accvgpr_write_b32 a20, 0
    v_accvgpr_write_b32 a21, 0
    v_accvgpr_write_b32 a22, 0
    v_accvgpr_write_b32 a23, 0
    v_accvgpr_write_b32 a36, 0
    v_accvgpr_write_b32 a37, 0
    v_accvgpr_write_b32 a38, 0
    v_accvgpr_write_b32 a39, 0
    v_accvgpr_write_b32 a52, 0
    v_accvgpr_write_b32 a53, 0
    v_accvgpr_write_b32 a54, 0
    v_accvgpr_write_b32 a55, 0
    v_accvgpr_write_b32 a68, 0
    v_accvgpr_write_b32 a69, 0
    v_accvgpr_write_b32 a70, 0
    v_accvgpr_write_b32 a71, 0
    v_accvgpr_write_b32 a84, 0
    v_accvgpr_write_b32 a85, 0
    v_accvgpr_write_b32 a86, 0
    v_accvgpr_write_b32 a87, 0
    v_accvgpr_write_b32 a100, 0
    v_accvgpr_write_b32 a101, 0
    v_accvgpr_write_b32 a102, 0
    v_accvgpr_write_b32 a103, 0
    v_accvgpr_write_b32 a116, 0
    v_accvgpr_write_b32 a117, 0
    v_accvgpr_write_b32 a118, 0
    v_accvgpr_write_b32 a119, 0
    s_mov_b32 s76, 0
L_slowl1_standalone__tree_speculative_verify_tree_attention_over_candidate_token_tree__prompt_kernel:
    s_cmp_lt_u32 s76, 64
    s_cselect_b32 s64, s24, s40
    s_cselect_b32 s72, s28, s44
    s_cselect_b32 s65, s25, s41
    s_cselect_b32 s73, s29, s45
    s_mov_b32 s66, 524288
    s_mov_b32 s67, 0x20000
    s_mov_b32 s74, 524288
    s_mov_b32 s75, 0x20000
    s_and_b32 s77, s76, 63
    s_lshl_b32 s77, s77, 13
    s_add_u32 m0, s78, 0
    s_add_u32 s60, s77, 0
    buffer_load_dwordx4 v44, s[64:67], s60 offen lds
    s_add_u32 m0, s78, 1024
    s_add_u32 s60, s77, 1024
    buffer_load_dwordx4 v45, s[64:67], s60 offen lds
    s_add_u32 m0, s78, 2048
    s_add_u32 s60, s77, 2048
    buffer_load_dwordx4 v44, s[64:67], s60 offen lds
    s_add_u32 m0, s78, 3072
    s_add_u32 s60, s77, 3072
    buffer_load_dwordx4 v45, s[64:67], s60 offen lds
    s_add_u32 m0, s78, 4096
    s_add_u32 s60, s77, 4096
    buffer_load_dwordx4 v44, s[64:67], s60 offen lds
    s_add_u32 m0, s78, 5120
    s_add_u32 s60, s77, 5120
    buffer_load_dwordx4 v45, s[64:67], s60 offen lds
    s_add_u32 m0, s78, 6144
    s_add_u32 s60, s77, 6144
    buffer_load_dwordx4 v44, s[64:67], s60 offen lds
    s_add_u32 m0, s78, 7168
    s_add_u32 s60, s77, 7168
    buffer_load_dwordx4 v45, s[64:67], s60 offen lds
    s_add_u32 m0, s78, 8192
    s_add_u32 s60, s77, 0
    buffer_load_dwordx4 v44, s[72:75], s60 offen lds
    s_add_u32 m0, s78, 9216
    s_add_u32 s60, s77, 1024
    buffer_load_dwordx4 v45, s[72:75], s60 offen lds
    s_add_u32 m0, s78, 10240
    s_add_u32 s60, s77, 2048
    buffer_load_dwordx4 v44, s[72:75], s60 offen lds
    s_add_u32 m0, s78, 11264
    s_add_u32 s60, s77, 3072
    buffer_load_dwordx4 v45, s[72:75], s60 offen lds
    s_add_u32 m0, s78, 12288
    s_add_u32 s60, s77, 4096
    buffer_load_dwordx4 v44, s[72:75], s60 offen lds
    s_add_u32 m0, s78, 13312
    s_add_u32 s60, s77, 5120
    buffer_load_dwordx4 v45, s[72:75], s60 offen lds
    s_add_u32 m0, s78, 14336
    s_add_u32 s60, s77, 6144
    buffer_load_dwordx4 v44, s[72:75], s60 offen lds
    s_add_u32 m0, s78, 15360
    s_add_u32 s60, s77, 7168
    buffer_load_dwordx4 v45, s[72:75], s60 offen lds
    s_add_u32 s60, s59, 8
    s_lshl_b32 s60, s60, 12
    s_lshr_b32 s61, s77, 7
    s_add_u32 s60, s60, s61
    buffer_load_dwordx2 v[48:49], v56, s[88:91], s60 offen
    buffer_load_dwordx2 v[50:51], v56, s[88:91], s60 offen offset:32
    s_waitcnt vmcnt(0)
    ds_read_b128 a[204:207], v21 offset:0
    ds_read_b128 a[208:211], v22 offset:0
    ds_read_b128 a[212:215], v23 offset:0
    ds_read_b128 a[216:219], v24 offset:0
    ds_read_b128 a[220:223], v21 offset:4096
    ds_read_b128 a[224:227], v22 offset:4096
    ds_read_b128 a[228:231], v23 offset:4096
    ds_read_b128 a[232:235], v24 offset:4096
    s_waitcnt lgkmcnt(0)
    ds_read_b64_tr_b16 a[160:161], v25 offset:8192
    ds_read_b64_tr_b16 a[162:163], v25 offset:12288
    ds_read_b64_tr_b16 a[164:165], v26 offset:8192
    ds_read_b64_tr_b16 a[166:167], v26 offset:12288
    ds_read_b64_tr_b16 a[168:169], v27 offset:8192
    ds_read_b64_tr_b16 a[170:171], v27 offset:12288
    ds_read_b64_tr_b16 a[172:173], v28 offset:8192
    ds_read_b64_tr_b16 a[174:175], v28 offset:12288
    ds_read_b64_tr_b16 a[176:177], v29 offset:8192
    ds_read_b64_tr_b16 a[178:179], v29 offset:12288
    ds_read_b64_tr_b16 a[180:181], v30 offset:8192
    ds_read_b64_tr_b16 a[182:183], v30 offset:12288
    ds_read_b64_tr_b16 a[236:237], v31 offset:8192
    ds_read_b64_tr_b16 a[238:239], v31 offset:12288
    ds_read_b64_tr_b16 a[240:241], v0 offset:8192
    ds_read_b64_tr_b16 a[242:243], v0 offset:12288
    v_mfma_f32_16x16x32_bf16 v[32:35], a[204:207], v[176:179], 0
    v_mfma_f32_16x16x32_bf16 v[32:35], a[208:211], v[180:183], v[32:35]
    v_mfma_f32_16x16x32_bf16 v[32:35], a[212:215], v[184:187], v[32:35]
    v_mfma_f32_16x16x32_bf16 v[32:35], a[216:219], v[188:191], v[32:35]
    v_mfma_f32_16x16x32_bf16 v[36:39], a[220:223], v[176:179], 0
    v_mfma_f32_16x16x32_bf16 v[36:39], a[224:227], v[180:183], v[36:39]
    v_mfma_f32_16x16x32_bf16 v[36:39], a[228:231], v[184:187], v[36:39]
    v_mfma_f32_16x16x32_bf16 v[36:39], a[232:235], v[188:191], v[36:39]
    s_nop 7
    s_cmp_lt_u32 s76, 64
    s_cbranch_scc1 L_nomask1_standalone__tree_speculative_verify_tree_attention_over_candidate_token_tree__prompt_kernel
    s_mov_b32 s60, 0x3f80
    v_mov_b32 v59, 0xff800000
    v_and_b32 v57, 0xffff, v48
    v_cmp_eq_u32 vcc, s60, v57
    s_nop 1
    v_cndmask_b32 v32, v59, v32, vcc
    v_lshrrev_b32 v57, 16, v48
    v_cmp_eq_u32 vcc, s60, v57
    s_nop 1
    v_cndmask_b32 v33, v59, v33, vcc
    v_and_b32 v57, 0xffff, v49
    v_cmp_eq_u32 vcc, s60, v57
    s_nop 1
    v_cndmask_b32 v34, v59, v34, vcc
    v_lshrrev_b32 v57, 16, v49
    v_cmp_eq_u32 vcc, s60, v57
    s_nop 1
    v_cndmask_b32 v35, v59, v35, vcc
    v_and_b32 v57, 0xffff, v50
    v_cmp_eq_u32 vcc, s60, v57
    s_nop 1
    v_cndmask_b32 v36, v59, v36, vcc
    v_lshrrev_b32 v57, 16, v50
    v_cmp_eq_u32 vcc, s60, v57
    s_nop 1
    v_cndmask_b32 v37, v59, v37, vcc
    v_and_b32 v57, 0xffff, v51
    v_cmp_eq_u32 vcc, s60, v57
    s_nop 1
    v_cndmask_b32 v38, v59, v38, vcc
    v_lshrrev_b32 v57, 16, v51
    v_cmp_eq_u32 vcc, s60, v57
    s_nop 1
    v_cndmask_b32 v39, v59, v39, vcc
L_nomask1_standalone__tree_speculative_verify_tree_attention_over_candidate_token_tree__prompt_kernel:
    v_max3_f32 v57, v32, v33, v34
    v_max3_f32 v57, v57, v35, v36
    v_max3_f32 v57, v57, v37, v38
    v_max_f32 v57, v57, v39
    ds_bpermute_b32 v58, v54, v57
    s_waitcnt lgkmcnt(0)
    v_max_f32 v57, v57, v58
    ds_bpermute_b32 v58, v55, v57
    s_waitcnt lgkmcnt(0)
    v_max_f32 v57, v57, v58
    v_max_f32 v57, v57, v52
    v_sub_f32 v58, v52, v57
    v_exp_f32 v58, v58
    v_mov_b32 v52, v57
    v_sub_f32 v32, v32, v52
    v_exp_f32 v32, v32
    v_sub_f32 v33, v33, v52
    v_exp_f32 v33, v33
    v_sub_f32 v34, v34, v52
    v_exp_f32 v34, v34
    v_sub_f32 v35, v35, v52
    v_exp_f32 v35, v35
    v_sub_f32 v36, v36, v52
    v_exp_f32 v36, v36
    v_sub_f32 v37, v37, v52
    v_exp_f32 v37, v37
    v_sub_f32 v38, v38, v52
    v_exp_f32 v38, v38
    v_sub_f32 v39, v39, v52
    v_exp_f32 v39, v39
    v_mul_f32 v53, v53, v58
    v_add_f32 v53, v53, v32
    v_add_f32 v53, v53, v33
    v_add_f32 v53, v53, v34
    v_add_f32 v53, v53, v35
    v_add_f32 v53, v53, v36
    v_add_f32 v53, v53, v37
    v_add_f32 v53, v53, v38
    v_add_f32 v53, v53, v39
    v_accvgpr_read_b32 v59, a4
    v_mul_f32 v59, v59, v58
    v_accvgpr_write_b32 a4, v59
    v_accvgpr_read_b32 v59, a5
    v_mul_f32 v59, v59, v58
    v_accvgpr_write_b32 a5, v59
    v_accvgpr_read_b32 v59, a6
    v_mul_f32 v59, v59, v58
    v_accvgpr_write_b32 a6, v59
    v_accvgpr_read_b32 v59, a7
    v_mul_f32 v59, v59, v58
    v_accvgpr_write_b32 a7, v59
    v_accvgpr_read_b32 v59, a20
    v_mul_f32 v59, v59, v58
    v_accvgpr_write_b32 a20, v59
    v_accvgpr_read_b32 v59, a21
    v_mul_f32 v59, v59, v58
    v_accvgpr_write_b32 a21, v59
    v_accvgpr_read_b32 v59, a22
    v_mul_f32 v59, v59, v58
    v_accvgpr_write_b32 a22, v59
    v_accvgpr_read_b32 v59, a23
    v_mul_f32 v59, v59, v58
    v_accvgpr_write_b32 a23, v59
    v_accvgpr_read_b32 v59, a36
    v_mul_f32 v59, v59, v58
    v_accvgpr_write_b32 a36, v59
    v_accvgpr_read_b32 v59, a37
    v_mul_f32 v59, v59, v58
    v_accvgpr_write_b32 a37, v59
    v_accvgpr_read_b32 v59, a38
    v_mul_f32 v59, v59, v58
    v_accvgpr_write_b32 a38, v59
    v_accvgpr_read_b32 v59, a39
    v_mul_f32 v59, v59, v58
    v_accvgpr_write_b32 a39, v59
    v_accvgpr_read_b32 v59, a52
    v_mul_f32 v59, v59, v58
    v_accvgpr_write_b32 a52, v59
    v_accvgpr_read_b32 v59, a53
    v_mul_f32 v59, v59, v58
    v_accvgpr_write_b32 a53, v59
    v_accvgpr_read_b32 v59, a54
    v_mul_f32 v59, v59, v58
    v_accvgpr_write_b32 a54, v59
    v_accvgpr_read_b32 v59, a55
    v_mul_f32 v59, v59, v58
    v_accvgpr_write_b32 a55, v59
    v_accvgpr_read_b32 v59, a68
    v_mul_f32 v59, v59, v58
    v_accvgpr_write_b32 a68, v59
    v_accvgpr_read_b32 v59, a69
    v_mul_f32 v59, v59, v58
    v_accvgpr_write_b32 a69, v59
    v_accvgpr_read_b32 v59, a70
    v_mul_f32 v59, v59, v58
    v_accvgpr_write_b32 a70, v59
    v_accvgpr_read_b32 v59, a71
    v_mul_f32 v59, v59, v58
    v_accvgpr_write_b32 a71, v59
    v_accvgpr_read_b32 v59, a84
    v_mul_f32 v59, v59, v58
    v_accvgpr_write_b32 a84, v59
    v_accvgpr_read_b32 v59, a85
    v_mul_f32 v59, v59, v58
    v_accvgpr_write_b32 a85, v59
    v_accvgpr_read_b32 v59, a86
    v_mul_f32 v59, v59, v58
    v_accvgpr_write_b32 a86, v59
    v_accvgpr_read_b32 v59, a87
    v_mul_f32 v59, v59, v58
    v_accvgpr_write_b32 a87, v59
    v_accvgpr_read_b32 v59, a100
    v_mul_f32 v59, v59, v58
    v_accvgpr_write_b32 a100, v59
    v_accvgpr_read_b32 v59, a101
    v_mul_f32 v59, v59, v58
    v_accvgpr_write_b32 a101, v59
    v_accvgpr_read_b32 v59, a102
    v_mul_f32 v59, v59, v58
    v_accvgpr_write_b32 a102, v59
    v_accvgpr_read_b32 v59, a103
    v_mul_f32 v59, v59, v58
    v_accvgpr_write_b32 a103, v59
    v_accvgpr_read_b32 v59, a116
    v_mul_f32 v59, v59, v58
    v_accvgpr_write_b32 a116, v59
    v_accvgpr_read_b32 v59, a117
    v_mul_f32 v59, v59, v58
    v_accvgpr_write_b32 a117, v59
    v_accvgpr_read_b32 v59, a118
    v_mul_f32 v59, v59, v58
    v_accvgpr_write_b32 a118, v59
    v_accvgpr_read_b32 v59, a119
    v_mul_f32 v59, v59, v58
    v_accvgpr_write_b32 a119, v59
    v_cvt_pk_bf16_f32 v40, v32, v33
    v_cvt_pk_bf16_f32 v41, v34, v35
    v_cvt_pk_bf16_f32 v42, v36, v37
    v_cvt_pk_bf16_f32 v43, v38, v39
    s_waitcnt lgkmcnt(0)
    s_nop 1
    v_mfma_f32_16x16x32_bf16 a[4:7], a[160:163], v[40:43], a[4:7]
    v_mfma_f32_16x16x32_bf16 a[20:23], a[164:167], v[40:43], a[20:23]
    v_mfma_f32_16x16x32_bf16 a[36:39], a[168:171], v[40:43], a[36:39]
    v_mfma_f32_16x16x32_bf16 a[52:55], a[172:175], v[40:43], a[52:55]
    v_mfma_f32_16x16x32_bf16 a[68:71], a[176:179], v[40:43], a[68:71]
    v_mfma_f32_16x16x32_bf16 a[84:87], a[180:183], v[40:43], a[84:87]
    v_mfma_f32_16x16x32_bf16 a[100:103], a[236:239], v[40:43], a[100:103]
    v_mfma_f32_16x16x32_bf16 a[116:119], a[240:243], v[40:43], a[116:119]
    s_nop 7
    s_add_u32 s76, s76, 1
    s_cmp_lt_u32 s76, 128
    s_cbranch_scc1 L_slowl1_standalone__tree_speculative_verify_tree_attention_over_candidate_token_tree__prompt_kernel
    ds_bpermute_b32 v58, v54, v53
    s_waitcnt lgkmcnt(0)
    v_add_f32 v53, v53, v58
    ds_bpermute_b32 v58, v55, v53
    s_waitcnt lgkmcnt(0)
    v_add_f32 v53, v53, v58
    v_accvgpr_write_b32 a188, v53
    v_accvgpr_write_b32 a189, 0
    v_lshrrev_b32 v57, 4, v246
    v_xor_b32 v54, 16, v57
    v_lshlrev_b32 v54, 2, v54
    v_xor_b32 v55, 32, v57
    v_lshlrev_b32 v55, 2, v55
    v_and_b32 v58, 7, v57
    v_lshlrev_b32 v58, 12, v58
    v_lshrrev_b32 v59, 4, v57
    v_lshl_add_u32 v56, v59, 3, v58
    v_subrev_u32 v44, s58, v14
    v_subrev_u32 v45, s58, v15
    s_mov_b32 s88, s14
    s_and_b32 s89, s15, 0xffff
    s_mov_b32 s90, 0x800000
    s_mov_b32 s91, 0x20000
    v_mov_b32 v52, 0xff800000
    v_mov_b32 v53, 0
    v_accvgpr_write_b32 a8, 0
    v_accvgpr_write_b32 a9, 0
    v_accvgpr_write_b32 a10, 0
    v_accvgpr_write_b32 a11, 0
    v_accvgpr_write_b32 a24, 0
    v_accvgpr_write_b32 a25, 0
    v_accvgpr_write_b32 a26, 0
    v_accvgpr_write_b32 a27, 0
    v_accvgpr_write_b32 a40, 0
    v_accvgpr_write_b32 a41, 0
    v_accvgpr_write_b32 a42, 0
    v_accvgpr_write_b32 a43, 0
    v_accvgpr_write_b32 a56, 0
    v_accvgpr_write_b32 a57, 0
    v_accvgpr_write_b32 a58, 0
    v_accvgpr_write_b32 a59, 0
    v_accvgpr_write_b32 a72, 0
    v_accvgpr_write_b32 a73, 0
    v_accvgpr_write_b32 a74, 0
    v_accvgpr_write_b32 a75, 0
    v_accvgpr_write_b32 a88, 0
    v_accvgpr_write_b32 a89, 0
    v_accvgpr_write_b32 a90, 0
    v_accvgpr_write_b32 a91, 0
    v_accvgpr_write_b32 a104, 0
    v_accvgpr_write_b32 a105, 0
    v_accvgpr_write_b32 a106, 0
    v_accvgpr_write_b32 a107, 0
    v_accvgpr_write_b32 a120, 0
    v_accvgpr_write_b32 a121, 0
    v_accvgpr_write_b32 a122, 0
    v_accvgpr_write_b32 a123, 0
    s_mov_b32 s76, 0
L_slowl2_standalone__tree_speculative_verify_tree_attention_over_candidate_token_tree__prompt_kernel:
    s_cmp_lt_u32 s76, 64
    s_cselect_b32 s64, s24, s40
    s_cselect_b32 s72, s28, s44
    s_cselect_b32 s65, s25, s41
    s_cselect_b32 s73, s29, s45
    s_mov_b32 s66, 524288
    s_mov_b32 s67, 0x20000
    s_mov_b32 s74, 524288
    s_mov_b32 s75, 0x20000
    s_and_b32 s77, s76, 63
    s_lshl_b32 s77, s77, 13
    s_add_u32 m0, s78, 0
    s_add_u32 s60, s77, 0
    buffer_load_dwordx4 v44, s[64:67], s60 offen lds
    s_add_u32 m0, s78, 1024
    s_add_u32 s60, s77, 1024
    buffer_load_dwordx4 v45, s[64:67], s60 offen lds
    s_add_u32 m0, s78, 2048
    s_add_u32 s60, s77, 2048
    buffer_load_dwordx4 v44, s[64:67], s60 offen lds
    s_add_u32 m0, s78, 3072
    s_add_u32 s60, s77, 3072
    buffer_load_dwordx4 v45, s[64:67], s60 offen lds
    s_add_u32 m0, s78, 4096
    s_add_u32 s60, s77, 4096
    buffer_load_dwordx4 v44, s[64:67], s60 offen lds
    s_add_u32 m0, s78, 5120
    s_add_u32 s60, s77, 5120
    buffer_load_dwordx4 v45, s[64:67], s60 offen lds
    s_add_u32 m0, s78, 6144
    s_add_u32 s60, s77, 6144
    buffer_load_dwordx4 v44, s[64:67], s60 offen lds
    s_add_u32 m0, s78, 7168
    s_add_u32 s60, s77, 7168
    buffer_load_dwordx4 v45, s[64:67], s60 offen lds
    s_add_u32 m0, s78, 8192
    s_add_u32 s60, s77, 0
    buffer_load_dwordx4 v44, s[72:75], s60 offen lds
    s_add_u32 m0, s78, 9216
    s_add_u32 s60, s77, 1024
    buffer_load_dwordx4 v45, s[72:75], s60 offen lds
    s_add_u32 m0, s78, 10240
    s_add_u32 s60, s77, 2048
    buffer_load_dwordx4 v44, s[72:75], s60 offen lds
    s_add_u32 m0, s78, 11264
    s_add_u32 s60, s77, 3072
    buffer_load_dwordx4 v45, s[72:75], s60 offen lds
    s_add_u32 m0, s78, 12288
    s_add_u32 s60, s77, 4096
    buffer_load_dwordx4 v44, s[72:75], s60 offen lds
    s_add_u32 m0, s78, 13312
    s_add_u32 s60, s77, 5120
    buffer_load_dwordx4 v45, s[72:75], s60 offen lds
    s_add_u32 m0, s78, 14336
    s_add_u32 s60, s77, 6144
    buffer_load_dwordx4 v44, s[72:75], s60 offen lds
    s_add_u32 m0, s78, 15360
    s_add_u32 s60, s77, 7168
    buffer_load_dwordx4 v45, s[72:75], s60 offen lds
    s_add_u32 s60, s59, 16
    s_lshl_b32 s60, s60, 12
    s_lshr_b32 s61, s77, 7
    s_add_u32 s60, s60, s61
    buffer_load_dwordx2 v[48:49], v56, s[88:91], s60 offen
    buffer_load_dwordx2 v[50:51], v56, s[88:91], s60 offen offset:32
    s_waitcnt vmcnt(0)
    ds_read_b128 a[204:207], v21 offset:0
    ds_read_b128 a[208:211], v22 offset:0
    ds_read_b128 a[212:215], v23 offset:0
    ds_read_b128 a[216:219], v24 offset:0
    ds_read_b128 a[220:223], v21 offset:4096
    ds_read_b128 a[224:227], v22 offset:4096
    ds_read_b128 a[228:231], v23 offset:4096
    ds_read_b128 a[232:235], v24 offset:4096
    s_waitcnt lgkmcnt(0)
    ds_read_b64_tr_b16 a[160:161], v25 offset:8192
    ds_read_b64_tr_b16 a[162:163], v25 offset:12288
    ds_read_b64_tr_b16 a[164:165], v26 offset:8192
    ds_read_b64_tr_b16 a[166:167], v26 offset:12288
    ds_read_b64_tr_b16 a[168:169], v27 offset:8192
    ds_read_b64_tr_b16 a[170:171], v27 offset:12288
    ds_read_b64_tr_b16 a[172:173], v28 offset:8192
    ds_read_b64_tr_b16 a[174:175], v28 offset:12288
    ds_read_b64_tr_b16 a[176:177], v29 offset:8192
    ds_read_b64_tr_b16 a[178:179], v29 offset:12288
    ds_read_b64_tr_b16 a[180:181], v30 offset:8192
    ds_read_b64_tr_b16 a[182:183], v30 offset:12288
    ds_read_b64_tr_b16 a[236:237], v31 offset:8192
    ds_read_b64_tr_b16 a[238:239], v31 offset:12288
    ds_read_b64_tr_b16 a[240:241], v0 offset:8192
    ds_read_b64_tr_b16 a[242:243], v0 offset:12288
    v_mfma_f32_16x16x32_bf16 v[32:35], a[204:207], v[192:195], 0
    v_mfma_f32_16x16x32_bf16 v[32:35], a[208:211], v[196:199], v[32:35]
    v_mfma_f32_16x16x32_bf16 v[32:35], a[212:215], v[200:203], v[32:35]
    v_mfma_f32_16x16x32_bf16 v[32:35], a[216:219], v[204:207], v[32:35]
    v_mfma_f32_16x16x32_bf16 v[36:39], a[220:223], v[192:195], 0
    v_mfma_f32_16x16x32_bf16 v[36:39], a[224:227], v[196:199], v[36:39]
    v_mfma_f32_16x16x32_bf16 v[36:39], a[228:231], v[200:203], v[36:39]
    v_mfma_f32_16x16x32_bf16 v[36:39], a[232:235], v[204:207], v[36:39]
    s_nop 7
    s_cmp_lt_u32 s76, 64
    s_cbranch_scc1 L_nomask2_standalone__tree_speculative_verify_tree_attention_over_candidate_token_tree__prompt_kernel
    s_mov_b32 s60, 0x3f80
    v_mov_b32 v59, 0xff800000
    v_and_b32 v57, 0xffff, v48
    v_cmp_eq_u32 vcc, s60, v57
    s_nop 1
    v_cndmask_b32 v32, v59, v32, vcc
    v_lshrrev_b32 v57, 16, v48
    v_cmp_eq_u32 vcc, s60, v57
    s_nop 1
    v_cndmask_b32 v33, v59, v33, vcc
    v_and_b32 v57, 0xffff, v49
    v_cmp_eq_u32 vcc, s60, v57
    s_nop 1
    v_cndmask_b32 v34, v59, v34, vcc
    v_lshrrev_b32 v57, 16, v49
    v_cmp_eq_u32 vcc, s60, v57
    s_nop 1
    v_cndmask_b32 v35, v59, v35, vcc
    v_and_b32 v57, 0xffff, v50
    v_cmp_eq_u32 vcc, s60, v57
    s_nop 1
    v_cndmask_b32 v36, v59, v36, vcc
    v_lshrrev_b32 v57, 16, v50
    v_cmp_eq_u32 vcc, s60, v57
    s_nop 1
    v_cndmask_b32 v37, v59, v37, vcc
    v_and_b32 v57, 0xffff, v51
    v_cmp_eq_u32 vcc, s60, v57
    s_nop 1
    v_cndmask_b32 v38, v59, v38, vcc
    v_lshrrev_b32 v57, 16, v51
    v_cmp_eq_u32 vcc, s60, v57
    s_nop 1
    v_cndmask_b32 v39, v59, v39, vcc
L_nomask2_standalone__tree_speculative_verify_tree_attention_over_candidate_token_tree__prompt_kernel:
    v_max3_f32 v57, v32, v33, v34
    v_max3_f32 v57, v57, v35, v36
    v_max3_f32 v57, v57, v37, v38
    v_max_f32 v57, v57, v39
    ds_bpermute_b32 v58, v54, v57
    s_waitcnt lgkmcnt(0)
    v_max_f32 v57, v57, v58
    ds_bpermute_b32 v58, v55, v57
    s_waitcnt lgkmcnt(0)
    v_max_f32 v57, v57, v58
    v_max_f32 v57, v57, v52
    v_sub_f32 v58, v52, v57
    v_exp_f32 v58, v58
    v_mov_b32 v52, v57
    v_sub_f32 v32, v32, v52
    v_exp_f32 v32, v32
    v_sub_f32 v33, v33, v52
    v_exp_f32 v33, v33
    v_sub_f32 v34, v34, v52
    v_exp_f32 v34, v34
    v_sub_f32 v35, v35, v52
    v_exp_f32 v35, v35
    v_sub_f32 v36, v36, v52
    v_exp_f32 v36, v36
    v_sub_f32 v37, v37, v52
    v_exp_f32 v37, v37
    v_sub_f32 v38, v38, v52
    v_exp_f32 v38, v38
    v_sub_f32 v39, v39, v52
    v_exp_f32 v39, v39
    v_mul_f32 v53, v53, v58
    v_add_f32 v53, v53, v32
    v_add_f32 v53, v53, v33
    v_add_f32 v53, v53, v34
    v_add_f32 v53, v53, v35
    v_add_f32 v53, v53, v36
    v_add_f32 v53, v53, v37
    v_add_f32 v53, v53, v38
    v_add_f32 v53, v53, v39
    v_accvgpr_read_b32 v59, a8
    v_mul_f32 v59, v59, v58
    v_accvgpr_write_b32 a8, v59
    v_accvgpr_read_b32 v59, a9
    v_mul_f32 v59, v59, v58
    v_accvgpr_write_b32 a9, v59
    v_accvgpr_read_b32 v59, a10
    v_mul_f32 v59, v59, v58
    v_accvgpr_write_b32 a10, v59
    v_accvgpr_read_b32 v59, a11
    v_mul_f32 v59, v59, v58
    v_accvgpr_write_b32 a11, v59
    v_accvgpr_read_b32 v59, a24
    v_mul_f32 v59, v59, v58
    v_accvgpr_write_b32 a24, v59
    v_accvgpr_read_b32 v59, a25
    v_mul_f32 v59, v59, v58
    v_accvgpr_write_b32 a25, v59
    v_accvgpr_read_b32 v59, a26
    v_mul_f32 v59, v59, v58
    v_accvgpr_write_b32 a26, v59
    v_accvgpr_read_b32 v59, a27
    v_mul_f32 v59, v59, v58
    v_accvgpr_write_b32 a27, v59
    v_accvgpr_read_b32 v59, a40
    v_mul_f32 v59, v59, v58
    v_accvgpr_write_b32 a40, v59
    v_accvgpr_read_b32 v59, a41
    v_mul_f32 v59, v59, v58
    v_accvgpr_write_b32 a41, v59
    v_accvgpr_read_b32 v59, a42
    v_mul_f32 v59, v59, v58
    v_accvgpr_write_b32 a42, v59
    v_accvgpr_read_b32 v59, a43
    v_mul_f32 v59, v59, v58
    v_accvgpr_write_b32 a43, v59
    v_accvgpr_read_b32 v59, a56
    v_mul_f32 v59, v59, v58
    v_accvgpr_write_b32 a56, v59
    v_accvgpr_read_b32 v59, a57
    v_mul_f32 v59, v59, v58
    v_accvgpr_write_b32 a57, v59
    v_accvgpr_read_b32 v59, a58
    v_mul_f32 v59, v59, v58
    v_accvgpr_write_b32 a58, v59
    v_accvgpr_read_b32 v59, a59
    v_mul_f32 v59, v59, v58
    v_accvgpr_write_b32 a59, v59
    v_accvgpr_read_b32 v59, a72
    v_mul_f32 v59, v59, v58
    v_accvgpr_write_b32 a72, v59
    v_accvgpr_read_b32 v59, a73
    v_mul_f32 v59, v59, v58
    v_accvgpr_write_b32 a73, v59
    v_accvgpr_read_b32 v59, a74
    v_mul_f32 v59, v59, v58
    v_accvgpr_write_b32 a74, v59
    v_accvgpr_read_b32 v59, a75
    v_mul_f32 v59, v59, v58
    v_accvgpr_write_b32 a75, v59
    v_accvgpr_read_b32 v59, a88
    v_mul_f32 v59, v59, v58
    v_accvgpr_write_b32 a88, v59
    v_accvgpr_read_b32 v59, a89
    v_mul_f32 v59, v59, v58
    v_accvgpr_write_b32 a89, v59
    v_accvgpr_read_b32 v59, a90
    v_mul_f32 v59, v59, v58
    v_accvgpr_write_b32 a90, v59
    v_accvgpr_read_b32 v59, a91
    v_mul_f32 v59, v59, v58
    v_accvgpr_write_b32 a91, v59
    v_accvgpr_read_b32 v59, a104
    v_mul_f32 v59, v59, v58
    v_accvgpr_write_b32 a104, v59
    v_accvgpr_read_b32 v59, a105
    v_mul_f32 v59, v59, v58
    v_accvgpr_write_b32 a105, v59
    v_accvgpr_read_b32 v59, a106
    v_mul_f32 v59, v59, v58
    v_accvgpr_write_b32 a106, v59
    v_accvgpr_read_b32 v59, a107
    v_mul_f32 v59, v59, v58
    v_accvgpr_write_b32 a107, v59
    v_accvgpr_read_b32 v59, a120
    v_mul_f32 v59, v59, v58
    v_accvgpr_write_b32 a120, v59
    v_accvgpr_read_b32 v59, a121
    v_mul_f32 v59, v59, v58
    v_accvgpr_write_b32 a121, v59
    v_accvgpr_read_b32 v59, a122
    v_mul_f32 v59, v59, v58
    v_accvgpr_write_b32 a122, v59
    v_accvgpr_read_b32 v59, a123
    v_mul_f32 v59, v59, v58
    v_accvgpr_write_b32 a123, v59
    v_cvt_pk_bf16_f32 v40, v32, v33
    v_cvt_pk_bf16_f32 v41, v34, v35
    v_cvt_pk_bf16_f32 v42, v36, v37
    v_cvt_pk_bf16_f32 v43, v38, v39
    s_waitcnt lgkmcnt(0)
    s_nop 1
    v_mfma_f32_16x16x32_bf16 a[8:11], a[160:163], v[40:43], a[8:11]
    v_mfma_f32_16x16x32_bf16 a[24:27], a[164:167], v[40:43], a[24:27]
    v_mfma_f32_16x16x32_bf16 a[40:43], a[168:171], v[40:43], a[40:43]
    v_mfma_f32_16x16x32_bf16 a[56:59], a[172:175], v[40:43], a[56:59]
    v_mfma_f32_16x16x32_bf16 a[72:75], a[176:179], v[40:43], a[72:75]
    v_mfma_f32_16x16x32_bf16 a[88:91], a[180:183], v[40:43], a[88:91]
    v_mfma_f32_16x16x32_bf16 a[104:107], a[236:239], v[40:43], a[104:107]
    v_mfma_f32_16x16x32_bf16 a[120:123], a[240:243], v[40:43], a[120:123]
    s_nop 7
    s_add_u32 s76, s76, 1
    s_cmp_lt_u32 s76, 128
    s_cbranch_scc1 L_slowl2_standalone__tree_speculative_verify_tree_attention_over_candidate_token_tree__prompt_kernel
    ds_bpermute_b32 v58, v54, v53
    s_waitcnt lgkmcnt(0)
    v_add_f32 v53, v53, v58
    ds_bpermute_b32 v58, v55, v53
    s_waitcnt lgkmcnt(0)
    v_add_f32 v53, v53, v58
    v_accvgpr_write_b32 a192, v53
    v_accvgpr_write_b32 a193, 0
    v_lshrrev_b32 v57, 4, v246
    v_xor_b32 v54, 16, v57
    v_lshlrev_b32 v54, 2, v54
    v_xor_b32 v55, 32, v57
    v_lshlrev_b32 v55, 2, v55
    v_and_b32 v58, 7, v57
    v_lshlrev_b32 v58, 12, v58
    v_lshrrev_b32 v59, 4, v57
    v_lshl_add_u32 v56, v59, 3, v58
    v_subrev_u32 v44, s58, v14
    v_subrev_u32 v45, s58, v15
    s_mov_b32 s88, s14
    s_and_b32 s89, s15, 0xffff
    s_mov_b32 s90, 0x800000
    s_mov_b32 s91, 0x20000
    v_mov_b32 v52, 0xff800000
    v_mov_b32 v53, 0
    v_accvgpr_write_b32 a12, 0
    v_accvgpr_write_b32 a13, 0
    v_accvgpr_write_b32 a14, 0
    v_accvgpr_write_b32 a15, 0
    v_accvgpr_write_b32 a28, 0
    v_accvgpr_write_b32 a29, 0
    v_accvgpr_write_b32 a30, 0
    v_accvgpr_write_b32 a31, 0
    v_accvgpr_write_b32 a44, 0
    v_accvgpr_write_b32 a45, 0
    v_accvgpr_write_b32 a46, 0
    v_accvgpr_write_b32 a47, 0
    v_accvgpr_write_b32 a60, 0
    v_accvgpr_write_b32 a61, 0
    v_accvgpr_write_b32 a62, 0
    v_accvgpr_write_b32 a63, 0
    v_accvgpr_write_b32 a76, 0
    v_accvgpr_write_b32 a77, 0
    v_accvgpr_write_b32 a78, 0
    v_accvgpr_write_b32 a79, 0
    v_accvgpr_write_b32 a92, 0
    v_accvgpr_write_b32 a93, 0
    v_accvgpr_write_b32 a94, 0
    v_accvgpr_write_b32 a95, 0
    v_accvgpr_write_b32 a108, 0
    v_accvgpr_write_b32 a109, 0
    v_accvgpr_write_b32 a110, 0
    v_accvgpr_write_b32 a111, 0
    v_accvgpr_write_b32 a124, 0
    v_accvgpr_write_b32 a125, 0
    v_accvgpr_write_b32 a126, 0
    v_accvgpr_write_b32 a127, 0
    s_mov_b32 s76, 0
L_slowl3_standalone__tree_speculative_verify_tree_attention_over_candidate_token_tree__prompt_kernel:
    s_cmp_lt_u32 s76, 64
    s_cselect_b32 s64, s24, s40
    s_cselect_b32 s72, s28, s44
    s_cselect_b32 s65, s25, s41
    s_cselect_b32 s73, s29, s45
    s_mov_b32 s66, 524288
    s_mov_b32 s67, 0x20000
    s_mov_b32 s74, 524288
    s_mov_b32 s75, 0x20000
    s_and_b32 s77, s76, 63
    s_lshl_b32 s77, s77, 13
    s_add_u32 m0, s78, 0
    s_add_u32 s60, s77, 0
    buffer_load_dwordx4 v44, s[64:67], s60 offen lds
    s_add_u32 m0, s78, 1024
    s_add_u32 s60, s77, 1024
    buffer_load_dwordx4 v45, s[64:67], s60 offen lds
    s_add_u32 m0, s78, 2048
    s_add_u32 s60, s77, 2048
    buffer_load_dwordx4 v44, s[64:67], s60 offen lds
    s_add_u32 m0, s78, 3072
    s_add_u32 s60, s77, 3072
    buffer_load_dwordx4 v45, s[64:67], s60 offen lds
    s_add_u32 m0, s78, 4096
    s_add_u32 s60, s77, 4096
    buffer_load_dwordx4 v44, s[64:67], s60 offen lds
    s_add_u32 m0, s78, 5120
    s_add_u32 s60, s77, 5120
    buffer_load_dwordx4 v45, s[64:67], s60 offen lds
    s_add_u32 m0, s78, 6144
    s_add_u32 s60, s77, 6144
    buffer_load_dwordx4 v44, s[64:67], s60 offen lds
    s_add_u32 m0, s78, 7168
    s_add_u32 s60, s77, 7168
    buffer_load_dwordx4 v45, s[64:67], s60 offen lds
    s_add_u32 m0, s78, 8192
    s_add_u32 s60, s77, 0
    buffer_load_dwordx4 v44, s[72:75], s60 offen lds
    s_add_u32 m0, s78, 9216
    s_add_u32 s60, s77, 1024
    buffer_load_dwordx4 v45, s[72:75], s60 offen lds
    s_add_u32 m0, s78, 10240
    s_add_u32 s60, s77, 2048
    buffer_load_dwordx4 v44, s[72:75], s60 offen lds
    s_add_u32 m0, s78, 11264
    s_add_u32 s60, s77, 3072
    buffer_load_dwordx4 v45, s[72:75], s60 offen lds
    s_add_u32 m0, s78, 12288
    s_add_u32 s60, s77, 4096
    buffer_load_dwordx4 v44, s[72:75], s60 offen lds
    s_add_u32 m0, s78, 13312
    s_add_u32 s60, s77, 5120
    buffer_load_dwordx4 v45, s[72:75], s60 offen lds
    s_add_u32 m0, s78, 14336
    s_add_u32 s60, s77, 6144
    buffer_load_dwordx4 v44, s[72:75], s60 offen lds
    s_add_u32 m0, s78, 15360
    s_add_u32 s60, s77, 7168
    buffer_load_dwordx4 v45, s[72:75], s60 offen lds
    s_add_u32 s60, s59, 24
    s_lshl_b32 s60, s60, 12
    s_lshr_b32 s61, s77, 7
    s_add_u32 s60, s60, s61
    buffer_load_dwordx2 v[48:49], v56, s[88:91], s60 offen
    buffer_load_dwordx2 v[50:51], v56, s[88:91], s60 offen offset:32
    s_waitcnt vmcnt(0)
    ds_read_b128 a[204:207], v21 offset:0
    ds_read_b128 a[208:211], v22 offset:0
    ds_read_b128 a[212:215], v23 offset:0
    ds_read_b128 a[216:219], v24 offset:0
    ds_read_b128 a[220:223], v21 offset:4096
    ds_read_b128 a[224:227], v22 offset:4096
    ds_read_b128 a[228:231], v23 offset:4096
    ds_read_b128 a[232:235], v24 offset:4096
    s_waitcnt lgkmcnt(0)
    ds_read_b64_tr_b16 a[160:161], v25 offset:8192
    ds_read_b64_tr_b16 a[162:163], v25 offset:12288
    ds_read_b64_tr_b16 a[164:165], v26 offset:8192
    ds_read_b64_tr_b16 a[166:167], v26 offset:12288
    ds_read_b64_tr_b16 a[168:169], v27 offset:8192
    ds_read_b64_tr_b16 a[170:171], v27 offset:12288
    ds_read_b64_tr_b16 a[172:173], v28 offset:8192
    ds_read_b64_tr_b16 a[174:175], v28 offset:12288
    ds_read_b64_tr_b16 a[176:177], v29 offset:8192
    ds_read_b64_tr_b16 a[178:179], v29 offset:12288
    ds_read_b64_tr_b16 a[180:181], v30 offset:8192
    ds_read_b64_tr_b16 a[182:183], v30 offset:12288
    ds_read_b64_tr_b16 a[236:237], v31 offset:8192
    ds_read_b64_tr_b16 a[238:239], v31 offset:12288
    ds_read_b64_tr_b16 a[240:241], v0 offset:8192
    ds_read_b64_tr_b16 a[242:243], v0 offset:12288
    v_mfma_f32_16x16x32_bf16 v[32:35], a[204:207], v[208:211], 0
    v_mfma_f32_16x16x32_bf16 v[32:35], a[208:211], v[212:215], v[32:35]
    v_mfma_f32_16x16x32_bf16 v[32:35], a[212:215], v[216:219], v[32:35]
    v_mfma_f32_16x16x32_bf16 v[32:35], a[216:219], v[220:223], v[32:35]
    v_mfma_f32_16x16x32_bf16 v[36:39], a[220:223], v[208:211], 0
    v_mfma_f32_16x16x32_bf16 v[36:39], a[224:227], v[212:215], v[36:39]
    v_mfma_f32_16x16x32_bf16 v[36:39], a[228:231], v[216:219], v[36:39]
    v_mfma_f32_16x16x32_bf16 v[36:39], a[232:235], v[220:223], v[36:39]
    s_nop 7
    s_cmp_lt_u32 s76, 64
    s_cbranch_scc1 L_nomask3_standalone__tree_speculative_verify_tree_attention_over_candidate_token_tree__prompt_kernel
    s_mov_b32 s60, 0x3f80
    v_mov_b32 v59, 0xff800000
    v_and_b32 v57, 0xffff, v48
    v_cmp_eq_u32 vcc, s60, v57
    s_nop 1
    v_cndmask_b32 v32, v59, v32, vcc
    v_lshrrev_b32 v57, 16, v48
    v_cmp_eq_u32 vcc, s60, v57
    s_nop 1
    v_cndmask_b32 v33, v59, v33, vcc
    v_and_b32 v57, 0xffff, v49
    v_cmp_eq_u32 vcc, s60, v57
    s_nop 1
    v_cndmask_b32 v34, v59, v34, vcc
    v_lshrrev_b32 v57, 16, v49
    v_cmp_eq_u32 vcc, s60, v57
    s_nop 1
    v_cndmask_b32 v35, v59, v35, vcc
    v_and_b32 v57, 0xffff, v50
    v_cmp_eq_u32 vcc, s60, v57
    s_nop 1
    v_cndmask_b32 v36, v59, v36, vcc
    v_lshrrev_b32 v57, 16, v50
    v_cmp_eq_u32 vcc, s60, v57
    s_nop 1
    v_cndmask_b32 v37, v59, v37, vcc
    v_and_b32 v57, 0xffff, v51
    v_cmp_eq_u32 vcc, s60, v57
    s_nop 1
    v_cndmask_b32 v38, v59, v38, vcc
    v_lshrrev_b32 v57, 16, v51
    v_cmp_eq_u32 vcc, s60, v57
    s_nop 1
    v_cndmask_b32 v39, v59, v39, vcc
L_nomask3_standalone__tree_speculative_verify_tree_attention_over_candidate_token_tree__prompt_kernel:
    v_max3_f32 v57, v32, v33, v34
    v_max3_f32 v57, v57, v35, v36
    v_max3_f32 v57, v57, v37, v38
    v_max_f32 v57, v57, v39
    ds_bpermute_b32 v58, v54, v57
    s_waitcnt lgkmcnt(0)
    v_max_f32 v57, v57, v58
    ds_bpermute_b32 v58, v55, v57
    s_waitcnt lgkmcnt(0)
    v_max_f32 v57, v57, v58
    v_max_f32 v57, v57, v52
    v_sub_f32 v58, v52, v57
    v_exp_f32 v58, v58
    v_mov_b32 v52, v57
    v_sub_f32 v32, v32, v52
    v_exp_f32 v32, v32
    v_sub_f32 v33, v33, v52
    v_exp_f32 v33, v33
    v_sub_f32 v34, v34, v52
    v_exp_f32 v34, v34
    v_sub_f32 v35, v35, v52
    v_exp_f32 v35, v35
    v_sub_f32 v36, v36, v52
    v_exp_f32 v36, v36
    v_sub_f32 v37, v37, v52
    v_exp_f32 v37, v37
    v_sub_f32 v38, v38, v52
    v_exp_f32 v38, v38
    v_sub_f32 v39, v39, v52
    v_exp_f32 v39, v39
    v_mul_f32 v53, v53, v58
    v_add_f32 v53, v53, v32
    v_add_f32 v53, v53, v33
    v_add_f32 v53, v53, v34
    v_add_f32 v53, v53, v35
    v_add_f32 v53, v53, v36
    v_add_f32 v53, v53, v37
    v_add_f32 v53, v53, v38
    v_add_f32 v53, v53, v39
    v_accvgpr_read_b32 v59, a12
    v_mul_f32 v59, v59, v58
    v_accvgpr_write_b32 a12, v59
    v_accvgpr_read_b32 v59, a13
    v_mul_f32 v59, v59, v58
    v_accvgpr_write_b32 a13, v59
    v_accvgpr_read_b32 v59, a14
    v_mul_f32 v59, v59, v58
    v_accvgpr_write_b32 a14, v59
    v_accvgpr_read_b32 v59, a15
    v_mul_f32 v59, v59, v58
    v_accvgpr_write_b32 a15, v59
    v_accvgpr_read_b32 v59, a28
    v_mul_f32 v59, v59, v58
    v_accvgpr_write_b32 a28, v59
    v_accvgpr_read_b32 v59, a29
    v_mul_f32 v59, v59, v58
    v_accvgpr_write_b32 a29, v59
    v_accvgpr_read_b32 v59, a30
    v_mul_f32 v59, v59, v58
    v_accvgpr_write_b32 a30, v59
    v_accvgpr_read_b32 v59, a31
    v_mul_f32 v59, v59, v58
    v_accvgpr_write_b32 a31, v59
    v_accvgpr_read_b32 v59, a44
    v_mul_f32 v59, v59, v58
    v_accvgpr_write_b32 a44, v59
    v_accvgpr_read_b32 v59, a45
    v_mul_f32 v59, v59, v58
    v_accvgpr_write_b32 a45, v59
    v_accvgpr_read_b32 v59, a46
    v_mul_f32 v59, v59, v58
    v_accvgpr_write_b32 a46, v59
    v_accvgpr_read_b32 v59, a47
    v_mul_f32 v59, v59, v58
    v_accvgpr_write_b32 a47, v59
    v_accvgpr_read_b32 v59, a60
    v_mul_f32 v59, v59, v58
    v_accvgpr_write_b32 a60, v59
    v_accvgpr_read_b32 v59, a61
    v_mul_f32 v59, v59, v58
    v_accvgpr_write_b32 a61, v59
    v_accvgpr_read_b32 v59, a62
    v_mul_f32 v59, v59, v58
    v_accvgpr_write_b32 a62, v59
    v_accvgpr_read_b32 v59, a63
    v_mul_f32 v59, v59, v58
    v_accvgpr_write_b32 a63, v59
    v_accvgpr_read_b32 v59, a76
    v_mul_f32 v59, v59, v58
    v_accvgpr_write_b32 a76, v59
    v_accvgpr_read_b32 v59, a77
    v_mul_f32 v59, v59, v58
    v_accvgpr_write_b32 a77, v59
    v_accvgpr_read_b32 v59, a78
    v_mul_f32 v59, v59, v58
    v_accvgpr_write_b32 a78, v59
    v_accvgpr_read_b32 v59, a79
    v_mul_f32 v59, v59, v58
    v_accvgpr_write_b32 a79, v59
    v_accvgpr_read_b32 v59, a92
    v_mul_f32 v59, v59, v58
    v_accvgpr_write_b32 a92, v59
    v_accvgpr_read_b32 v59, a93
    v_mul_f32 v59, v59, v58
    v_accvgpr_write_b32 a93, v59
    v_accvgpr_read_b32 v59, a94
    v_mul_f32 v59, v59, v58
    v_accvgpr_write_b32 a94, v59
    v_accvgpr_read_b32 v59, a95
    v_mul_f32 v59, v59, v58
    v_accvgpr_write_b32 a95, v59
    v_accvgpr_read_b32 v59, a108
    v_mul_f32 v59, v59, v58
    v_accvgpr_write_b32 a108, v59
    v_accvgpr_read_b32 v59, a109
    v_mul_f32 v59, v59, v58
    v_accvgpr_write_b32 a109, v59
    v_accvgpr_read_b32 v59, a110
    v_mul_f32 v59, v59, v58
    v_accvgpr_write_b32 a110, v59
    v_accvgpr_read_b32 v59, a111
    v_mul_f32 v59, v59, v58
    v_accvgpr_write_b32 a111, v59
    v_accvgpr_read_b32 v59, a124
    v_mul_f32 v59, v59, v58
    v_accvgpr_write_b32 a124, v59
    v_accvgpr_read_b32 v59, a125
    v_mul_f32 v59, v59, v58
    v_accvgpr_write_b32 a125, v59
    v_accvgpr_read_b32 v59, a126
    v_mul_f32 v59, v59, v58
    v_accvgpr_write_b32 a126, v59
    v_accvgpr_read_b32 v59, a127
    v_mul_f32 v59, v59, v58
    v_accvgpr_write_b32 a127, v59
    v_cvt_pk_bf16_f32 v40, v32, v33
    v_cvt_pk_bf16_f32 v41, v34, v35
    v_cvt_pk_bf16_f32 v42, v36, v37
    v_cvt_pk_bf16_f32 v43, v38, v39
    s_waitcnt lgkmcnt(0)
    s_nop 1
    v_mfma_f32_16x16x32_bf16 a[12:15], a[160:163], v[40:43], a[12:15]
    v_mfma_f32_16x16x32_bf16 a[28:31], a[164:167], v[40:43], a[28:31]
    v_mfma_f32_16x16x32_bf16 a[44:47], a[168:171], v[40:43], a[44:47]
    v_mfma_f32_16x16x32_bf16 a[60:63], a[172:175], v[40:43], a[60:63]
    v_mfma_f32_16x16x32_bf16 a[76:79], a[176:179], v[40:43], a[76:79]
    v_mfma_f32_16x16x32_bf16 a[92:95], a[180:183], v[40:43], a[92:95]
    v_mfma_f32_16x16x32_bf16 a[108:111], a[236:239], v[40:43], a[108:111]
    v_mfma_f32_16x16x32_bf16 a[124:127], a[240:243], v[40:43], a[124:127]
    s_nop 7
    s_add_u32 s76, s76, 1
    s_cmp_lt_u32 s76, 128
    s_cbranch_scc1 L_slowl3_standalone__tree_speculative_verify_tree_attention_over_candidate_token_tree__prompt_kernel
    ds_bpermute_b32 v58, v54, v53
    s_waitcnt lgkmcnt(0)
    v_add_f32 v53, v53, v58
    ds_bpermute_b32 v58, v55, v53
    s_waitcnt lgkmcnt(0)
    v_add_f32 v53, v53, v58
    v_accvgpr_write_b32 a196, v53
    v_accvgpr_write_b32 a197, 0
    v_lshrrev_b32 v240, 4, v246
    v_and_b32 v238, 15, v240
    v_lshrrev_b32 v239, 4, v240
    v_lshrrev_b32 v240, 1, v239
    v_xor_b32 v240, v240, v238
    v_and_b32 v241, 1, v239
    v_lshlrev_b32 v241, 3, v241
    v_lshl_add_u32 v241, v238, 8, v241
    v_add_u32 v241, s78, v241
    v_xor_b32 v224, 0, v240
    v_lshl_add_u32 v224, v224, 4, v241
    v_xor_b32 v225, 2, v240
    v_lshl_add_u32 v225, v225, 4, v241
    v_xor_b32 v226, 4, v240
    v_lshl_add_u32 v226, v226, 4, v241
    v_xor_b32 v227, 6, v240
    v_lshl_add_u32 v227, v227, 4, v241
    v_xor_b32 v228, 8, v240
    v_lshl_add_u32 v228, v228, 4, v241
    v_xor_b32 v229, 10, v240
    v_lshl_add_u32 v229, v229, 4, v241
    v_xor_b32 v230, 12, v240
    v_lshl_add_u32 v230, v230, 4, v241
    v_xor_b32 v231, 14, v240
    v_lshl_add_u32 v231, v231, 4, v241
    v_lshlrev_b32 v241, 8, v239
    v_add_u32 v241, s78, v241
    v_add_u32 v232, 0, v239
    v_xor_b32 v232, v232, v238
    v_lshl_add_u32 v232, v232, 4, v241
    v_add_u32 v233, 4, v239
    v_xor_b32 v233, v233, v238
    v_lshl_add_u32 v233, v233, 4, v241
    v_add_u32 v234, 8, v239
    v_xor_b32 v234, v234, v238
    v_lshl_add_u32 v234, v234, 4, v241
    v_add_u32 v235, 12, v239
    v_xor_b32 v235, v235, v238
    v_lshl_add_u32 v235, v235, 4, v241
    s_nop 7
    s_mov_b64 s[70:71], exec
    s_mov_b32 s64, 0x35800000
    s_mov_b32 s65, 0x71800000
    v_accvgpr_read_b32 v236, a184
    v_accvgpr_read_b32 v237, a185
    v_accvgpr_read_b32 v32, a0
    v_add_f32 v236, v236, v237
    v_accvgpr_read_b32 v33, a1
    v_cmp_lt_f32 vcc, s64, v236
    v_accvgpr_read_b32 v34, a2
    v_accvgpr_read_b32 v35, a3
    s_and_b64 s[70:71], s[70:71], vcc
    v_cmp_gt_f32 vcc, s65, v236
    v_rcp_f32 v236, v236
    v_accvgpr_read_b32 v36, a16
    v_accvgpr_read_b32 v37, a17
    v_accvgpr_read_b32 v38, a18
    v_accvgpr_read_b32 v39, a19
    v_accvgpr_read_b32 v40, a32
    v_accvgpr_read_b32 v41, a33
    v_accvgpr_read_b32 v42, a34
    v_accvgpr_read_b32 v43, a35
    v_accvgpr_read_b32 v44, a48
    v_accvgpr_read_b32 v45, a49
    v_accvgpr_read_b32 v46, a50
    v_accvgpr_read_b32 v47, a51
    v_accvgpr_read_b32 v48, a64
    v_accvgpr_read_b32 v49, a65
    v_accvgpr_read_b32 v50, a66
    v_accvgpr_read_b32 v51, a67
    v_accvgpr_read_b32 v52, a80
    v_accvgpr_read_b32 v53, a81
    v_accvgpr_read_b32 v54, a82
    v_accvgpr_read_b32 v55, a83
    v_accvgpr_read_b32 v56, a96
    v_accvgpr_read_b32 v57, a97
    v_accvgpr_read_b32 v58, a98
    v_accvgpr_read_b32 v59, a99
    v_accvgpr_read_b32 v60, a112
    v_accvgpr_read_b32 v61, a113
    v_accvgpr_read_b32 v62, a114
    v_accvgpr_read_b32 v63, a115
    s_and_b64 s[70:71], s[70:71], vcc
    v_mul_f32 v32, v236, v32
    v_mul_f32 v33, v236, v33
    v_mul_f32 v34, v236, v34
    v_mul_f32 v35, v236, v35
    v_mul_f32 v36, v236, v36
    v_mul_f32 v37, v236, v37
    v_mul_f32 v38, v236, v38
    v_mul_f32 v39, v236, v39
    v_mul_f32 v40, v236, v40
    v_mul_f32 v41, v236, v41
    v_mul_f32 v42, v236, v42
    v_mul_f32 v43, v236, v43
    v_mul_f32 v44, v236, v44
    v_mul_f32 v45, v236, v45
    v_mul_f32 v46, v236, v46
    v_mul_f32 v47, v236, v47
    v_mul_f32 v48, v236, v48
    v_mul_f32 v49, v236, v49
    v_mul_f32 v50, v236, v50
    v_mul_f32 v51, v236, v51
    v_mul_f32 v52, v236, v52
    v_mul_f32 v53, v236, v53
    v_mul_f32 v54, v236, v54
    v_mul_f32 v55, v236, v55
    v_mul_f32 v56, v236, v56
    v_mul_f32 v57, v236, v57
    v_mul_f32 v58, v236, v58
    v_mul_f32 v59, v236, v59
    v_mul_f32 v60, v236, v60
    v_mul_f32 v61, v236, v61
    v_mul_f32 v62, v236, v62
    v_mul_f32 v63, v236, v63
    v_cvt_pk_bf16_f32 v128, v32, v33
    v_cvt_pk_bf16_f32 v129, v34, v35
    v_cvt_pk_bf16_f32 v130, v36, v37
    v_cvt_pk_bf16_f32 v131, v38, v39
    ds_write_b64 v224, v[128:129] offset:0
    v_cvt_pk_bf16_f32 v132, v40, v41
    v_cvt_pk_bf16_f32 v133, v42, v43
    ds_write_b64 v225, v[130:131] offset:0
    v_mfma_f32_16x16x32_bf16 a[244:247], a[248:251], v[128:131], 0
    v_cvt_pk_bf16_f32 v134, v44, v45
    v_cvt_pk_bf16_f32 v135, v46, v47
    ds_write_b64 v226, v[132:133] offset:0
    v_cvt_pk_bf16_f32 v136, v48, v49
    v_cvt_pk_bf16_f32 v137, v50, v51
    ds_write_b64 v227, v[134:135] offset:0
    v_mfma_f32_16x16x32_bf16 a[244:247], a[248:251], v[132:135], a[244:247]
    v_cvt_pk_bf16_f32 v138, v52, v53
    v_cvt_pk_bf16_f32 v139, v54, v55
    ds_write_b64 v228, v[136:137] offset:0
    v_cvt_pk_bf16_f32 v140, v56, v57
    v_cvt_pk_bf16_f32 v141, v58, v59
    ds_write_b64 v229, v[138:139] offset:0
    v_mfma_f32_16x16x32_bf16 a[244:247], a[248:251], v[136:139], a[244:247]
    v_cvt_pk_bf16_f32 v142, v60, v61
    v_cvt_pk_bf16_f32 v143, v62, v63
    ds_write_b64 v230, v[140:141] offset:0
    ds_write_b64 v231, v[142:143] offset:0
    s_nop 0
    v_mfma_f32_16x16x32_bf16 a[244:247], a[248:251], v[140:143], a[244:247]
    v_accvgpr_read_b32 v236, a188
    v_accvgpr_read_b32 v237, a189
    v_accvgpr_read_b32 v64, a4
    v_add_f32 v236, v236, v237
    v_accvgpr_read_b32 v65, a5
    v_cmp_lt_f32 vcc, s64, v236
    v_accvgpr_read_b32 v66, a6
    v_accvgpr_read_b32 v67, a7
    s_and_b64 s[70:71], s[70:71], vcc
    v_cmp_gt_f32 vcc, s65, v236
    v_rcp_f32 v236, v236
    v_accvgpr_read_b32 v68, a20
    v_accvgpr_read_b32 v69, a21
    v_accvgpr_read_b32 v70, a22
    v_accvgpr_read_b32 v71, a23
    v_accvgpr_read_b32 v72, a36
    v_accvgpr_read_b32 v73, a37
    v_accvgpr_read_b32 v74, a38
    v_accvgpr_read_b32 v75, a39
    v_accvgpr_read_b32 v76, a52
    v_accvgpr_read_b32 v77, a53
    v_accvgpr_read_b32 v78, a54
    v_accvgpr_read_b32 v79, a55
    v_accvgpr_read_b32 v80, a68
    v_accvgpr_read_b32 v81, a69
    v_accvgpr_read_b32 v82, a70
    v_accvgpr_read_b32 v83, a71
    v_accvgpr_read_b32 v84, a84
    v_accvgpr_read_b32 v85, a85
    v_accvgpr_read_b32 v86, a86
    v_accvgpr_read_b32 v87, a87
    v_accvgpr_read_b32 v88, a100
    v_accvgpr_read_b32 v89, a101
    v_accvgpr_read_b32 v90, a102
    v_accvgpr_read_b32 v91, a103
    v_accvgpr_read_b32 v92, a116
    v_accvgpr_read_b32 v93, a117
    v_accvgpr_read_b32 v94, a118
    v_accvgpr_read_b32 v95, a119
    s_and_b64 s[70:71], s[70:71], vcc
    v_mul_f32 v64, v236, v64
    v_mul_f32 v65, v236, v65
    v_mul_f32 v66, v236, v66
    v_mul_f32 v67, v236, v67
    v_mul_f32 v68, v236, v68
    v_mul_f32 v69, v236, v69
    v_mul_f32 v70, v236, v70
    v_mul_f32 v71, v236, v71
    v_mul_f32 v72, v236, v72
    v_mul_f32 v73, v236, v73
    v_mul_f32 v74, v236, v74
    v_mul_f32 v75, v236, v75
    v_mul_f32 v76, v236, v76
    v_mul_f32 v77, v236, v77
    v_mul_f32 v78, v236, v78
    v_mul_f32 v79, v236, v79
    v_mul_f32 v80, v236, v80
    v_mul_f32 v81, v236, v81
    v_mul_f32 v82, v236, v82
    v_mul_f32 v83, v236, v83
    v_mul_f32 v84, v236, v84
    v_mul_f32 v85, v236, v85
    v_mul_f32 v86, v236, v86
    v_mul_f32 v87, v236, v87
    v_mul_f32 v88, v236, v88
    v_mul_f32 v89, v236, v89
    v_mul_f32 v90, v236, v90
    v_mul_f32 v91, v236, v91
    v_mul_f32 v92, v236, v92
    v_mul_f32 v93, v236, v93
    v_mul_f32 v94, v236, v94
    v_mul_f32 v95, v236, v95
    s_waitcnt lgkmcnt(0)
    ds_read_b128 v[32:35], v232 offset:0
    ds_read_b128 v[36:39], v233 offset:1024
    ds_read_b128 v[40:43], v234 offset:2048
    ds_read_b128 v[44:47], v235 offset:3072
    v_cvt_pk_bf16_f32 v144, v64, v65
    v_cvt_pk_bf16_f32 v145, v66, v67
    v_cvt_pk_bf16_f32 v146, v68, v69
    v_cvt_pk_bf16_f32 v147, v70, v71
    ds_write_b64 v224, v[144:145] offset:4096
    v_cvt_pk_bf16_f32 v148, v72, v73
    v_cvt_pk_bf16_f32 v149, v74, v75
    ds_write_b64 v225, v[146:147] offset:4096
    v_mfma_f32_16x16x32_bf16 a[244:247], a[248:251], v[144:147], a[244:247]
    v_cvt_pk_bf16_f32 v150, v76, v77
    v_cvt_pk_bf16_f32 v151, v78, v79
    ds_write_b64 v226, v[148:149] offset:4096
    v_cvt_pk_bf16_f32 v152, v80, v81
    v_cvt_pk_bf16_f32 v153, v82, v83
    ds_write_b64 v227, v[150:151] offset:4096
    v_mfma_f32_16x16x32_bf16 a[244:247], a[248:251], v[148:151], a[244:247]
    v_cvt_pk_bf16_f32 v154, v84, v85
    v_cvt_pk_bf16_f32 v155, v86, v87
    ds_write_b64 v228, v[152:153] offset:4096
    v_cvt_pk_bf16_f32 v156, v88, v89
    v_cvt_pk_bf16_f32 v157, v90, v91
    ds_write_b64 v229, v[154:155] offset:4096
    v_mfma_f32_16x16x32_bf16 a[244:247], a[248:251], v[152:155], a[244:247]
    v_cvt_pk_bf16_f32 v158, v92, v93
    v_cvt_pk_bf16_f32 v159, v94, v95
    ds_write_b64 v230, v[156:157] offset:4096
    ds_write_b64 v231, v[158:159] offset:4096
    s_nop 0
    v_mfma_f32_16x16x32_bf16 a[244:247], a[248:251], v[156:159], a[244:247]
    s_waitcnt lgkmcnt(8)
    s_mov_b32 s62, 0
    buffer_store_dwordx4 v[32:35], v246, s[36:39], s62 offen sc0 sc1
    s_mov_b32 s62, 1024
    buffer_store_dwordx4 v[36:39], v246, s[36:39], s62 offen sc0 sc1
    s_mov_b32 s62, 524288
    buffer_store_dwordx4 v[40:43], v246, s[36:39], s62 offen sc0 sc1
    s_mov_b32 s62, 525312
    buffer_store_dwordx4 v[44:47], v246, s[36:39], s62 offen sc0 sc1
    v_accvgpr_read_b32 v236, a192
    v_accvgpr_read_b32 v237, a193
    v_accvgpr_read_b32 v96, a8
    v_add_f32 v236, v236, v237
    v_accvgpr_read_b32 v97, a9
    v_cmp_lt_f32 vcc, s64, v236
    v_accvgpr_read_b32 v98, a10
    v_accvgpr_read_b32 v99, a11
    s_and_b64 s[70:71], s[70:71], vcc
    v_cmp_gt_f32 vcc, s65, v236
    v_rcp_f32 v236, v236
    v_accvgpr_read_b32 v100, a24
    v_accvgpr_read_b32 v101, a25
    v_accvgpr_read_b32 v102, a26
    v_accvgpr_read_b32 v103, a27
    v_accvgpr_read_b32 v104, a40
    v_accvgpr_read_b32 v105, a41
    v_accvgpr_read_b32 v106, a42
    v_accvgpr_read_b32 v107, a43
    v_accvgpr_read_b32 v108, a56
    v_accvgpr_read_b32 v109, a57
    v_accvgpr_read_b32 v110, a58
    v_accvgpr_read_b32 v111, a59
    v_accvgpr_read_b32 v112, a72
    v_accvgpr_read_b32 v113, a73
    v_accvgpr_read_b32 v114, a74
    v_accvgpr_read_b32 v115, a75
    v_accvgpr_read_b32 v116, a88
    v_accvgpr_read_b32 v117, a89
    v_accvgpr_read_b32 v118, a90
    v_accvgpr_read_b32 v119, a91
    v_accvgpr_read_b32 v120, a104
    v_accvgpr_read_b32 v121, a105
    v_accvgpr_read_b32 v122, a106
    v_accvgpr_read_b32 v123, a107
    v_accvgpr_read_b32 v124, a120
    v_accvgpr_read_b32 v125, a121
    v_accvgpr_read_b32 v126, a122
    v_accvgpr_read_b32 v127, a123
    s_and_b64 s[70:71], s[70:71], vcc
    v_mul_f32 v96, v236, v96
    v_mul_f32 v97, v236, v97
    v_mul_f32 v98, v236, v98
    v_mul_f32 v99, v236, v99
    v_mul_f32 v100, v236, v100
    v_mul_f32 v101, v236, v101
    v_mul_f32 v102, v236, v102
    v_mul_f32 v103, v236, v103
    v_mul_f32 v104, v236, v104
    v_mul_f32 v105, v236, v105
    v_mul_f32 v106, v236, v106
    v_mul_f32 v107, v236, v107
    v_mul_f32 v108, v236, v108
    v_mul_f32 v109, v236, v109
    v_mul_f32 v110, v236, v110
    v_mul_f32 v111, v236, v111
    v_mul_f32 v112, v236, v112
    v_mul_f32 v113, v236, v113
    v_mul_f32 v114, v236, v114
    v_mul_f32 v115, v236, v115
    v_mul_f32 v116, v236, v116
    v_mul_f32 v117, v236, v117
    v_mul_f32 v118, v236, v118
    v_mul_f32 v119, v236, v119
    v_mul_f32 v120, v236, v120
    v_mul_f32 v121, v236, v121
    v_mul_f32 v122, v236, v122
    v_mul_f32 v123, v236, v123
    v_mul_f32 v124, v236, v124
    v_mul_f32 v125, v236, v125
    v_mul_f32 v126, v236, v126
    v_mul_f32 v127, v236, v127
    s_waitcnt lgkmcnt(0)
    ds_read_b128 v[64:67], v232 offset:4096
    ds_read_b128 v[68:71], v233 offset:5120
    ds_read_b128 v[72:75], v234 offset:6144
    ds_read_b128 v[76:79], v235 offset:7168
    v_cvt_pk_bf16_f32 v128, v96, v97
    v_cvt_pk_bf16_f32 v129, v98, v99
    v_cvt_pk_bf16_f32 v130, v100, v101
    v_cvt_pk_bf16_f32 v131, v102, v103
    ds_write_b64 v224, v[128:129] offset:8192
    v_cvt_pk_bf16_f32 v132, v104, v105
    v_cvt_pk_bf16_f32 v133, v106, v107
    ds_write_b64 v225, v[130:131] offset:8192
    v_mfma_f32_16x16x32_bf16 a[244:247], a[248:251], v[128:131], a[244:247]
    v_cvt_pk_bf16_f32 v134, v108, v109
    v_cvt_pk_bf16_f32 v135, v110, v111
    ds_write_b64 v226, v[132:133] offset:8192
    v_cvt_pk_bf16_f32 v136, v112, v113
    v_cvt_pk_bf16_f32 v137, v114, v115
    ds_write_b64 v227, v[134:135] offset:8192
    v_mfma_f32_16x16x32_bf16 a[244:247], a[248:251], v[132:135], a[244:247]
    v_cvt_pk_bf16_f32 v138, v116, v117
    v_cvt_pk_bf16_f32 v139, v118, v119
    ds_write_b64 v228, v[136:137] offset:8192
    v_cvt_pk_bf16_f32 v140, v120, v121
    v_cvt_pk_bf16_f32 v141, v122, v123
    ds_write_b64 v229, v[138:139] offset:8192
    v_mfma_f32_16x16x32_bf16 a[244:247], a[248:251], v[136:139], a[244:247]
    v_cvt_pk_bf16_f32 v142, v124, v125
    v_cvt_pk_bf16_f32 v143, v126, v127
    ds_write_b64 v230, v[140:141] offset:8192
    ds_write_b64 v231, v[142:143] offset:8192
    s_nop 0
    v_mfma_f32_16x16x32_bf16 a[244:247], a[248:251], v[140:143], a[244:247]
    s_waitcnt lgkmcnt(8)
    s_mov_b32 s62, 2048
    buffer_store_dwordx4 v[64:67], v246, s[36:39], s62 offen sc0 sc1
    s_mov_b32 s62, 3072
    buffer_store_dwordx4 v[68:71], v246, s[36:39], s62 offen sc0 sc1
    s_mov_b32 s62, 526336
    buffer_store_dwordx4 v[72:75], v246, s[36:39], s62 offen sc0 sc1
    s_mov_b32 s62, 527360
    buffer_store_dwordx4 v[76:79], v246, s[36:39], s62 offen sc0 sc1
    v_accvgpr_read_b32 v236, a196
    v_accvgpr_read_b32 v237, a197
    v_accvgpr_read_b32 v32, a12
    v_add_f32 v236, v236, v237
    v_accvgpr_read_b32 v33, a13
    v_cmp_lt_f32 vcc, s64, v236
    v_accvgpr_read_b32 v34, a14
    v_accvgpr_read_b32 v35, a15
    s_and_b64 s[70:71], s[70:71], vcc
    v_cmp_gt_f32 vcc, s65, v236
    v_rcp_f32 v236, v236
    v_accvgpr_read_b32 v36, a28
    v_accvgpr_read_b32 v37, a29
    v_accvgpr_read_b32 v38, a30
    v_accvgpr_read_b32 v39, a31
    v_accvgpr_read_b32 v40, a44
    v_accvgpr_read_b32 v41, a45
    v_accvgpr_read_b32 v42, a46
    v_accvgpr_read_b32 v43, a47
    v_accvgpr_read_b32 v44, a60
    v_accvgpr_read_b32 v45, a61
    v_accvgpr_read_b32 v46, a62
    v_accvgpr_read_b32 v47, a63
    v_accvgpr_read_b32 v48, a76
    v_accvgpr_read_b32 v49, a77
    v_accvgpr_read_b32 v50, a78
    v_accvgpr_read_b32 v51, a79
    v_accvgpr_read_b32 v52, a92
    v_accvgpr_read_b32 v53, a93
    v_accvgpr_read_b32 v54, a94
    v_accvgpr_read_b32 v55, a95
    v_accvgpr_read_b32 v56, a108
    v_accvgpr_read_b32 v57, a109
    v_accvgpr_read_b32 v58, a110
    v_accvgpr_read_b32 v59, a111
    v_accvgpr_read_b32 v60, a124
    v_accvgpr_read_b32 v61, a125
    v_accvgpr_read_b32 v62, a126
    v_accvgpr_read_b32 v63, a127
    s_and_b64 s[70:71], s[70:71], vcc
    v_mul_f32 v32, v236, v32
    v_mul_f32 v33, v236, v33
    v_mul_f32 v34, v236, v34
    v_mul_f32 v35, v236, v35
    v_mul_f32 v36, v236, v36
    v_mul_f32 v37, v236, v37
    v_mul_f32 v38, v236, v38
    v_mul_f32 v39, v236, v39
    v_mul_f32 v40, v236, v40
    v_mul_f32 v41, v236, v41
    v_mul_f32 v42, v236, v42
    v_mul_f32 v43, v236, v43
    v_mul_f32 v44, v236, v44
    v_mul_f32 v45, v236, v45
    v_mul_f32 v46, v236, v46
    v_mul_f32 v47, v236, v47
    v_mul_f32 v48, v236, v48
    v_mul_f32 v49, v236, v49
    v_mul_f32 v50, v236, v50
    v_mul_f32 v51, v236, v51
    v_mul_f32 v52, v236, v52
    v_mul_f32 v53, v236, v53
    v_mul_f32 v54, v236, v54
    v_mul_f32 v55, v236, v55
    v_mul_f32 v56, v236, v56
    v_mul_f32 v57, v236, v57
    v_mul_f32 v58, v236, v58
    v_mul_f32 v59, v236, v59
    v_mul_f32 v60, v236, v60
    v_mul_f32 v61, v236, v61
    v_mul_f32 v62, v236, v62
    v_mul_f32 v63, v236, v63
    s_waitcnt lgkmcnt(0)
    ds_read_b128 v[80:83], v232 offset:8192
    ds_read_b128 v[84:87], v233 offset:9216
    ds_read_b128 v[88:91], v234 offset:10240
    ds_read_b128 v[92:95], v235 offset:11264
    v_cvt_pk_bf16_f32 v144, v32, v33
    v_cvt_pk_bf16_f32 v145, v34, v35
    v_cvt_pk_bf16_f32 v146, v36, v37
    v_cvt_pk_bf16_f32 v147, v38, v39
    ds_write_b64 v224, v[144:145] offset:12288
    v_cvt_pk_bf16_f32 v148, v40, v41
    v_cvt_pk_bf16_f32 v149, v42, v43
    ds_write_b64 v225, v[146:147] offset:12288
    v_mfma_f32_16x16x32_bf16 a[244:247], a[248:251], v[144:147], a[244:247]
    v_cvt_pk_bf16_f32 v150, v44, v45
    v_cvt_pk_bf16_f32 v151, v46, v47
    ds_write_b64 v226, v[148:149] offset:12288
    v_cvt_pk_bf16_f32 v152, v48, v49
    v_cvt_pk_bf16_f32 v153, v50, v51
    ds_write_b64 v227, v[150:151] offset:12288
    v_mfma_f32_16x16x32_bf16 a[244:247], a[248:251], v[148:151], a[244:247]
    v_cvt_pk_bf16_f32 v154, v52, v53
    v_cvt_pk_bf16_f32 v155, v54, v55
    ds_write_b64 v228, v[152:153] offset:12288
    v_cvt_pk_bf16_f32 v156, v56, v57
    v_cvt_pk_bf16_f32 v157, v58, v59
    ds_write_b64 v229, v[154:155] offset:12288
    v_mfma_f32_16x16x32_bf16 a[244:247], a[248:251], v[152:155], a[244:247]
    v_cvt_pk_bf16_f32 v158, v60, v61
    v_cvt_pk_bf16_f32 v159, v62, v63
    ds_write_b64 v230, v[156:157] offset:12288
    ds_write_b64 v231, v[158:159] offset:12288
    s_nop 0
    v_mfma_f32_16x16x32_bf16 a[244:247], a[248:251], v[156:159], a[244:247]
    s_waitcnt lgkmcnt(8)
    s_mov_b32 s62, 4096
    buffer_store_dwordx4 v[80:83], v246, s[36:39], s62 offen sc0 sc1
    s_mov_b32 s62, 5120
    buffer_store_dwordx4 v[84:87], v246, s[36:39], s62 offen sc0 sc1
    s_mov_b32 s62, 528384
    buffer_store_dwordx4 v[88:91], v246, s[36:39], s62 offen sc0 sc1
    s_mov_b32 s62, 529408
    buffer_store_dwordx4 v[92:95], v246, s[36:39], s62 offen sc0 sc1
    s_waitcnt lgkmcnt(0)
    ds_read_b128 v[96:99], v232 offset:12288
    ds_read_b128 v[100:103], v233 offset:13312
    ds_read_b128 v[104:107], v234 offset:14336
    ds_read_b128 v[108:111], v235 offset:15360
    v_accvgpr_read_b32 v32, a244
    v_accvgpr_read_b32 v33, a245
    v_accvgpr_read_b32 v34, a246
    v_accvgpr_read_b32 v35, a247
    s_mov_b32 s64, 0x207
    s_waitcnt lgkmcnt(0)
    s_mov_b32 s62, 6144
    buffer_store_dwordx4 v[96:99], v246, s[36:39], s62 offen sc0 sc1
    s_mov_b32 s62, 7168
    buffer_store_dwordx4 v[100:103], v246, s[36:39], s62 offen sc0 sc1
    s_mov_b32 s62, 530432
    buffer_store_dwordx4 v[104:107], v246, s[36:39], s62 offen sc0 sc1
    s_mov_b32 s62, 531456
    buffer_store_dwordx4 v[108:111], v246, s[36:39], s62 offen sc0 sc1
    v_cmp_class_f32 vcc, v32, s64
    s_mov_b64 s[74:75], 0
    s_nop 0
    s_or_b64 s[74:75], s[74:75], vcc
    v_cmp_class_f32 vcc, v33, s64
    s_nop 0
    s_or_b64 s[74:75], s[74:75], vcc
    v_cmp_class_f32 vcc, v34, s64
    s_nop 0
    s_or_b64 s[74:75], s[74:75], vcc
    v_cmp_class_f32 vcc, v35, s64
    s_nop 0
    s_or_b64 s[74:75], s[74:75], vcc
    s_xor_b64 s[70:71], s[70:71], exec
    s_or_b64 s[74:75], s[74:75], s[70:71]
    s_branch L_fin_standalone__tree_speculative_verify_tree_attention_over_candidate_token_tree__prompt_kernel
.section .rodata,"a"
.p2align 6
.amdhsa_kernel standalone__tree_speculative_verify_tree_attention_over_candidate_token_tree__prompt_kernel
  .amdhsa_next_free_vgpr 512
  .amdhsa_next_free_sgpr 102
  .amdhsa_accum_offset 256
  .amdhsa_group_segment_fixed_size 0
  .amdhsa_kernarg_size 72
  .amdhsa_user_sgpr_count 2
  .amdhsa_user_sgpr_kernarg_segment_ptr 1
  .amdhsa_system_sgpr_workgroup_id_x 1
.end_amdhsa_kernel
```
